```python
import torch

def _softmax(x, axis=-1):
    return torch.softmax(x, dim=axis)
def _gelu(x):
    return torch.nn.functional.gelu(x, approximate="tanh")
def _silu(x):
    return torch.nn.functional.silu(x)
def _sigmoid(x):
    return torch.sigmoid(x)
def _layernorm(x, axis=-1, eps=1e-5):
    m = x.mean(dim=axis, keepdim=True)
    v = x.var(dim=axis, keepdim=True, unbiased=False)
    return (x - m) / torch.sqrt(v + eps)
def _scatter_add(tgt, idx, src, axis=0):
    return tgt.clone().index_add_(axis, idx, src)
def _segment_sum(src, seg, n):
    out = torch.zeros((n,) + src.shape[1:], dtype=src.dtype)
    return out.index_add_(0, seg, src)
def _pad(x, pw):
    flat = tuple(v for pair in reversed(pw) for v in pair)
    return torch.nn.functional.pad(x, flat)

kernel_name = 'standalone__sequential_behavior_din__recsys'

def setup_inputs():

    _w = (lambda a: (lambda t: t.to(torch.bfloat16) if t.is_floating_point() else t)(torch.as_tensor(a)))
    B, L, D = 1024, 200, 128
    H = D
    return {
        "target": _w((lambda *s: torch.randn(*s, dtype=torch.bfloat16) * 1.6)(B, D)),
        "hist": _w((lambda *s: torch.randn(*s, dtype=torch.bfloat16) * 1.6)(B, L, D)),
        "mask": _w((lambda lo, hi, *s: torch.randint(lo, hi, s))(0, 2, B, L).to(float)),
        "w1": _w((lambda *s: torch.randn(*s, dtype=torch.bfloat16) * 1.6)(4 * D, H) * (4 * D) ** -0.5),
        "b1": _w((lambda *s: torch.randn(*s, dtype=torch.bfloat16) * 1.6)(H) * 0.1),
        "w2": _w((lambda *s: torch.randn(*s, dtype=torch.bfloat16) * 0.05)(H, 1) * H ** -0.5),
        "b2": _w((lambda *s: torch.randn(*s, dtype=torch.bfloat16) * 0.05)(1) * 0.1),
    }

def reference(target, hist, mask, w1, b1, w2, b2):
    L = hist.shape[1]
    tgt = (lambda x, n, axis: torch.repeat_interleave(x, n, dim=axis))(target[:, None, :], L, axis=1)
    feat = torch.concatenate([hist, tgt, hist - tgt, hist * tgt], axis=-1)
    h = _sigmoid(feat @ w1 + b1)
    scores = (h @ w2 + b2)[..., 0] * mask
    return torch.einsum('bl,bld->bd', scores, hist)
```

```asm
; @launch grid=(256,1,1) block=(256,1,1) lds=153600
.amdgcn_target "amdgcn-amd-amdhsa--gfx950"
.text
.globl standalone__sequential_behavior_din__recsys_kernel
.p2align 8
.type standalone__sequential_behavior_din__recsys_kernel,@function
standalone__sequential_behavior_din__recsys_kernel:
  s_cmp_ge_u32 s2, 256
  s_cbranch_scc1 L_end
  s_load_dwordx16 s[16:31], s[0:1], 0
  s_getpc_b64 s[12:13]
L_pc:
  v_lshrrev_b32 v108, 6, v0
  v_and_b32 v112, 63, v0
  v_readfirstlane_b32 s5, v108
  v_and_b32 v116, 1, v0
  s_bfe_u32 s7, s2, 0x50003
  s_lshl2_add_u32 s8, s7, s5
  s_lshl_b32 s7, s8, 8
  v_lshl_add_u32 v108, v116, 7, s7
  v_min_u32 v108, L_codeend-L_pc-4, v108
  global_load_dword v128, v108, s[12:13]
  v_and_b32 v109, 15, v0
  s_lshl_b32 s7, s8, 11
  s_and_b32 s7, s7, 0x1ffff
  v_lshl_add_u32 v109, v109, 7, s7
  v_and_b32 v122, 3, v0
  s_lshl_b32 s14, s5, 15
  s_mov_b32 s42, 400
  s_mov_b32 s43, 0x20000
  s_mov_b32 s46, 1024
  s_mov_b32 s47, 0x20000
  s_mov_b32 s50, 131072
  s_mov_b32 s51, 0x20000
  v_lshrrev_b32 v110, 2, v112
  v_lshlrev_b32 v110, 8, v110
  v_lshl_add_u32 v110, v122, 4, v110
  s_lshl_b32 s80, s5, 6
  v_add_u32 v56, s80, v110
  v_add_u32 v57, 3072, v56
  v_add_u32 v58, 63488, v56
  v_add_u32 v59, 66560, v56
  v_add_u32 v60, 32768, v56
  v_add_u32 v61, 35840, v56
  v_add_u32 v62, 96256, v56
  v_add_u32 v63, 99328, v56
  s_lshl_b32 s7, s5, 8
  v_lshl_add_u32 v110, v112, 2, s7
  v_lshlrev_b32 v111, 3, v112
  s_lshl2_add_u32 s4, s2, s5
  s_mul_i32 s8, s4, 400
  s_lshl_b32 s9, s2, 10
  s_movk_i32 s6, 8192
  s_movk_i32 s10, 16384
  s_movk_i32 s15, 24576
  s_add_u32 m0, s7, 139264
  v_lshrrev_b32 v114, 5, v112
  v_bfe_u32 v117, v112, 1, 1
  v_bfe_u32 v119, v112, 4, 1
  v_bfe_u32 v120, v112, 2, 1
  v_bfe_u32 v121, v112, 3, 1
  v_bfe_u32 v124, v112, 2, 2
  v_lshrrev_b32 v113, 4, v112
  v_and_b32 v115, 31, v112
  v_and_b32 v118, 0x13, v112
  v_lshl_or_b32 v118, v120, 3, v118
  v_lshl_or_b32 v118, v121, 2, v118
  v_cmp_eq_u32 s[76:77], v120, v119
  v_cmp_eq_u32 s[78:79], v120, v114
  v_mov_b32 v123, 1048576
  ds_read_b128 a[192:195], v123
  ds_read_b128 a[196:199], v123
  ds_read_b128 a[200:203], v123
  s_mov_b32 s33, 0xbfb8aa3b
  v_mov_b32 v136, 0
  v_mov_b32 v137, 0
  v_mov_b32 v138, 0
  v_mov_b32 v139, 0
  v_mov_b32 v140, 2.0
  v_mov_b32 v141, 2.0
  v_mov_b32 v142, 2.0
  v_mov_b32 v143, 2.0
  s_lshl_b32 s75, s5, 10
  s_add_u32 s75, s75, 131072
  s_lshl_b32 s81, s5, 11
  s_add_u32 s81, s81, 141312
  v_lshl_add_u32 v160, v112, 4, s75
  v_lshl_add_u32 v161, v112, 4, s81
  s_waitcnt lgkmcnt(0)
  v_mov_b32 v166, v109
  s_add_u32 s40, s20, s8
  s_addc_u32 s41, s21, 0
  s_add_u32 s44, s16, s9
  s_addc_u32 s45, s17, 0
  buffer_load_dword v132, v110, s[44:47], 0 offen
  buffer_load_dwordx2 v[130:131], v111, s[40:43], 0 offen
  s_mov_b32 s48, s22
  s_mov_b32 s49, s23
  buffer_load_dword v110, s[44:47], 0 offen  lds
  s_mov_b32 m0, 140288
  v_and_b32 v109, 15, v112
  v_lshlrev_b32 v109, 4, v109
  global_load_lds_dwordx4 v109, s[26:27]
  v_lshl_add_u32 v125, v118, 1, s80
  global_load_ushort v40, v125, s[24:25]
  global_load_ushort v42, v136, s[28:29]
  s_add_u32 m0, s14, 0
  s_nop 0
  buffer_load_dwordx4 v56, s[48:51], 0 offen offset:0  lds
  v_lshl_add_u32 v133, v112, 5, s81
  v_lshl_add_u32 v133, v122, 2, v133
  v_lshlrev_b32 v108, 5, v119
  v_lshl_add_u32 v108, v116, 4, v108
  v_lshl_add_u32 v108, v117, 3, v108
  buffer_load_dwordx4 v57, s[48:51], 0 offen offset:1024  lds
  v_lshl_add_u32 v108, v124, 6, v108
  v_lshl_add_u32 v108, v114, 9, v108
  v_add_u32 v32, s14, v108
  v_and_b32 v108, 15, v118
  v_lshlrev_b32 v108, 4, v108
  buffer_load_dwordx4 v58, s[48:51], 0 offen offset:2048  lds
  v_add_u32 v108, 141312, v108
  v_add_u32 v109, s5, v119
  v_and_b32 v109, 3, v109
  v_xor_b32 v110, 2, v109
  v_lshl_add_u32 v109, v109, 11, v108
  buffer_load_dwordx4 v59, s[48:51], 0 offen offset:3072  lds
  v_lshl_add_u32 v110, v110, 11, v108
  v_cndmask_b32 v33, v123, v109, s[78:79]
  v_cndmask_b32 v34, v123, v110, s[78:79]
  v_add_u32 v108, s5, v112
  v_and_b32 v108, 3, v108
  global_load_dword v167, v166, s[22:23]
  v_lshlrev_b32 v108, 8, v108
  v_lshl_add_u32 v108, v114, 4, v108
  v_add_u32 v108, 139264, v108
  v_cndmask_b32 v35, v123, v108, s[76:77]
  v_lshlrev_b32 v108, 4, v116
  s_add_u32 m0, s14, 4096
  s_nop 0
  buffer_load_dwordx4 v60, s[48:51], 0 offen offset:0  lds
  v_mov_b32 v109, 0xffff
  v_lshlrev_b32 v108, v108, v109
  v_cndmask_b32 v108, 0, v108, s[78:79]
  v_lshl_or_b32 v109, v121, 1, v117
  v_and_b32 v110, 0xbfb9bfb9, v108
  buffer_load_dwordx4 v61, s[48:51], 0 offen offset:1024  lds
  v_and_b32 v111, 0x3b2c3b2c, v108
  v_cmp_eq_u32 s[64:65], 0, v109
  v_cmp_eq_u32 s[66:67], 1, v109
  v_cmp_eq_u32 s[68:69], 2, v109
  v_cmp_eq_u32 s[70:71], 3, v109
  buffer_load_dwordx4 v62, s[48:51], 0 offen offset:2048  lds
  v_cndmask_b32 v24, 0, v110, s[64:65]
  v_cndmask_b32 v28, 0, v111, s[64:65]
  v_cndmask_b32 v25, 0, v110, s[66:67]
  v_cndmask_b32 v29, 0, v111, s[66:67]
  v_cndmask_b32 v26, 0, v110, s[68:69]
  buffer_load_dwordx4 v63, s[48:51], 0 offen offset:3072  lds
  v_cndmask_b32 v30, 0, v111, s[68:69]
  v_cndmask_b32 v27, 0, v110, s[70:71]
  v_cndmask_b32 v31, 0, v111, s[70:71]
  v_lshlrev_b32 v152, 10, v112
  v_add_u32 v153, 0x100, v152
  v_add_u32 v154, 0x200, v152
  v_add_u32 v155, 0x300, v152
  s_mul_i32 s8, s4, 51200
  s_sub_u32 s8, s8, 3072
  s_subb_u32 s7, 0, 0
  s_add_u32 s36, s18, s8
  s_addc_u32 s37, s19, s7
  s_lshl_b32 s8, s4, 8
  s_add_u32 s60, s30, s8
  s_addc_u32 s61, s31, 0
  s_mov_b32 s38, 54272
  s_mov_b32 s39, 0x20000
  s_mov_b32 s62, 256
  s_mov_b32 s63, 0x20000
  s_movk_i32 s52, 3072
  s_movk_i32 s53, 2048
  ds_write_b128 v161, v[136:139]
  s_movk_i32 s54, 1024
  s_movk_i32 s55, 96
  s_movk_i32 s72, 128
  s_movk_i32 s73, 160
  s_movk_i32 s74, 192
  s_movk_i32 s11, 224
  v_lshl_add_u32 v53, v113, 5, s75
  v_and_b32 v108, 15, v112
  v_xor_b32 v108, v119, v108
  v_lshlrev_b32 v54, 4, v108
  v_and_b32 v125, 7, v112
  v_lshl_or_b32 v126, v125, 1, v121
  ds_write_b128 v161, v[136:139] offset:1024
  v_xor_b32 v126, v126, v114
  v_lshlrev_b32 v126, 4, v126
  v_lshl_add_u32 v126, v125, 10, v126
  v_lshrrev_b32 v127, 3, v115
  v_lshl_add_u32 v126, v127, 8, v126
  v_add_u32 v8, s14, v126
  v_xor_b32 v9, 32, v8
  v_xor_b32 v10, 64, v8
  v_xor_b32 v11, s55, v8
  v_xor_b32 v12, s72, v8
  v_xor_b32 v13, s73, v8
  v_xor_b32 v14, s74, v8
  ds_write_b128 v160, v[140:143]
  v_xor_b32 v15, s11, v8
  v_bfe_u32 v125, v112, 2, 3
  v_lshl_or_b32 v126, v125, 1, v114
  v_xor_b32 v126, v126, v117
  v_lshlrev_b32 v126, 4, v126
  v_lshl_add_u32 v126, v125, 10, v126
  v_lshl_add_u32 v126, v114, 8, v126
  v_lshl_add_u32 v126, v116, 3, v126
  v_add_u32 v16, s14, v126
  v_xor_b32 v17, 32, v16
  v_xor_b32 v18, 64, v16
  v_xor_b32 v19, s55, v16
  ds_write_b128 v160, v[136:139] offset:4096
  v_xor_b32 v20, s72, v16
  v_xor_b32 v21, s73, v16
  v_xor_b32 v22, s74, v16
  v_xor_b32 v23, s11, v16
  v_lshlrev_b32 v125, 6, v116
  v_lshl_add_u32 v125, v113, 4, v125
  v_add_u32 v52, s75, v125
  v_lshl_add_u32 v36, v112, 4, s14
  s_mov_b32 s7, 0x1ffff
  v_add_u32 v37, 0x18000, v36
  v_xor_b32 v38, 0x10000, v36
  v_add_u32 v39, 0x8000, v36
  v_and_b32 v37, s7, v37
  v_and_b32 v39, s7, v39
  s_lshl_b32 s7, s5, 9
  s_add_u32 s7, s7, 149504
  v_lshl_add_u32 v41, v115, 4, s7
  v_cmp_eq_u32 vcc, v119, v116
  s_add_u32 s7, s80, 140288
  v_lshl_add_u32 v125, v114, 4, s7
  v_cndmask_b32 v43, v123, v125, vcc
  v_cmp_gt_u32 vcc, 32, v112
  v_mov_b32 v125, 0x3f803f80
  v_mov_b32 v126, 0x3f003f00
  v_cndmask_b32 v125, 0, v125, vcc
  s_waitcnt lgkmcnt(0)
  v_accvgpr_write_b32 a192, v126
  v_accvgpr_write_b32 a196, v125
  v_accvgpr_write_b32 a201, v125
  s_waitcnt vmcnt(11)
  v_and_b32 v135, 0xffff0000, v132
  v_lshlrev_b32 v132, 16, v132
  v_mul_f32 v132, s33, v132
  v_mul_f32 v135, s33, v135
  v_cvt_pk_bf16_f32 v132, v132, v135
  ds_write_b16 v133, v132
  ds_write_b16_d16_hi v133, v132 offset:18
  v_lshlrev_b32 v156, 16, v130
  v_and_b32 v157, 0xffff0000, v130
  v_lshlrev_b32 v158, 16, v131
  v_and_b32 v159, 0xffff0000, v131
  v_cmp_neq_f32 s[64:65], 0, v156
  v_cmp_neq_f32 s[66:67], 0, v157
  v_cmp_neq_f32 s[68:69], 0, v158
  v_cmp_neq_f32 s[70:71], 0, v159
  v_mbcnt_lo_u32_b32 v148, s64, 0
  s_bcnt1_i32_b64 s12, s[64:65]
  v_mbcnt_hi_u32_b32 v148, s65, v148
  s_bcnt1_i32_b64 s13, s[66:67]
  v_mbcnt_lo_u32_b32 v148, s66, v148
  s_bcnt1_i32_b64 s8, s[68:69]
  v_mbcnt_hi_u32_b32 v148, s67, v148
  s_bcnt1_i32_b64 s9, s[70:71]
  v_mbcnt_lo_u32_b32 v148, s68, v148
  s_add_u32 s12, s12, s13
  v_mbcnt_hi_u32_b32 v148, s69, v148
  s_add_u32 s8, s8, s9
  v_mbcnt_lo_u32_b32 v148, s70, v148
  s_add_u32 s13, s12, s8
  v_mbcnt_hi_u32_b32 v148, s71, v148
  s_add_u32 s32, s13, 31
  s_andn2_b32 s32, s32, 31
  s_max_u32 s32, s32, 128
  s_sub_u32 s32, s32, s13
  s_add_u32 m0, s14, 8192
  v_add_u32 v148, s32, v148
  buffer_load_dwordx4 v56, s[48:51], s6 offen offset:0  lds
  v_addc_co_u32 v149, s[78:79], v148, 0, s[64:65]
  v_addc_co_u32 v150, s[78:79], v149, 0, s[66:67]
  v_addc_co_u32 v151, s[78:79], v150, 0, s[68:69]
  v_and_or_b32 v144, v148, 28, s75
  v_and_or_b32 v145, v149, 28, s75
  v_and_or_b32 v146, v150, 28, s75
  v_and_or_b32 v147, v151, 28, s75
  v_and_b32 v162, 3, v148
  buffer_load_dwordx4 v57, s[48:51], s6 offen offset:1024  lds
  v_and_b32 v163, 3, v149
  v_and_b32 v164, 3, v150
  v_and_b32 v165, 3, v151
  v_lshrrev_b32 v148, 5, v148
  v_lshrrev_b32 v149, 5, v149
  v_lshrrev_b32 v150, 5, v150
  v_lshrrev_b32 v151, 5, v151
  v_lshl_add_u32 v144, v162, 5, v144
  v_lshl_add_u32 v145, v163, 5, v145
  buffer_load_dwordx4 v58, s[48:51], s6 offen offset:2048  lds
  v_lshl_add_u32 v146, v164, 5, v146
  v_lshl_add_u32 v147, v165, 5, v147
  v_lshl_add_u32 v148, v148, 7, v144
  v_lshl_add_u32 v149, v149, 7, v145
  v_lshl_add_u32 v150, v150, 7, v146
  v_lshl_add_u32 v151, v151, 7, v147
  s_mov_b64 exec, s[64:65]
  ds_write2st64_b32 v148, v152, v156 offset0:0 offset1:16
  s_mov_b64 exec, s[66:67]
  ds_write2st64_b32 v149, v153, v157 offset0:0 offset1:16
  s_mov_b64 exec, s[68:69]
  ds_write2st64_b32 v150, v154, v158 offset0:0 offset1:16
  s_mov_b64 exec, s[70:71]
  ds_write2st64_b32 v151, v155, v159 offset0:0 offset1:16
  s_mov_b64 exec, -1
  buffer_load_dwordx4 v59, s[48:51], s6 offen offset:3072  lds
  s_add_u32 m0, s14, 12288
  s_nop 0
  buffer_load_dwordx4 v60, s[48:51], s6 offen offset:0  lds
  s_waitcnt vmcnt(10)
  ds_read_b64_tr_b16 a[0:1], v32 offset:0
  ds_read_b64_tr_b16 a[2:3], v32 offset:256
  ds_read_b64_tr_b16 a[4:5], v32 offset:2048
  ds_read_b64_tr_b16 a[6:7], v32 offset:2304
  ds_read_b64_tr_b16 a[16:17], v32 offset:1024
  ds_read_b64_tr_b16 a[18:19], v32 offset:1280
  ds_read_b64_tr_b16 a[20:21], v32 offset:3072
  ds_read_b64_tr_b16 a[22:23], v32 offset:3328
  s_waitcnt vmcnt(5)
  ds_read_b64_tr_b16 a[12:13], v32 offset:6144
  ds_read_b64_tr_b16 a[14:15], v32 offset:6400
  ds_read_b64_tr_b16 a[8:9], v32 offset:4096
  ds_read_b64_tr_b16 a[10:11], v32 offset:4352
  ds_read_b64_tr_b16 a[28:29], v32 offset:7168
  ds_read_b64_tr_b16 a[30:31], v32 offset:7424
  ds_read_b64_tr_b16 a[24:25], v32 offset:5120
  ds_read_b64_tr_b16 a[26:27], v32 offset:5376
  s_waitcnt lgkmcnt(15)
  s_barrier
  buffer_load_dwordx4 v61, s[48:51], s6 offen offset:1024  lds
  ds_read_b128 v[4:7], v53
  ds_read_b128 v[0:3], v53 offset:128
  ds_read_b128 a[204:207], v33 offset:0
  s_waitcnt lgkmcnt(15)
  v_mfma_f32_32x32x16_bf16 v[96:111], v[24:27], a[0:3], 0
  buffer_load_dwordx4 v62, s[48:51], s6 offen offset:2048  lds
  ds_read_b128 a[208:211], v34 offset:0
  v_mfma_f32_32x32x16_bf16 v[96:111], v[24:27], a[4:7], v[96:111]
  ds_read_b128 a[212:215], v33 offset:256
  ds_read_b128 a[216:219], v34 offset:256
  buffer_load_dwordx4 v63, s[48:51], s6 offen offset:3072  lds
  s_add_u32 m0, s14, 16384
  v_mfma_f32_32x32x16_bf16 v[96:111], v[28:31], a[0:3], v[96:111]
  ds_read_b128 a[160:163], v35 offset:0
  ds_read_b128 a[164:167], v35 offset:32
  v_mfma_f32_32x32x16_bf16 v[96:111], v[28:31], a[4:7], v[96:111]
  buffer_load_dwordx4 v56, s[48:51], s10 offen offset:0  lds
  ds_read_b128 a[128:131], v43 offset:256
  s_waitcnt lgkmcnt(7)
  v_xad_u32 v0, v54, 0, v0
  v_xad_u32 v1, v54, 32, v1
  v_mfma_f32_32x32x16_bf16 v[112:127], v[24:27], a[16:19], 0
  ds_read_b128 a[132:135], v43 offset:288
  buffer_load_dwordx4 v57, s[48:51], s10 offen offset:1024  lds
  ds_read_b128 a[136:139], v43 offset:192
  s_waitcnt lgkmcnt(8)
  v_mfma_f32_32x32x16_bf16 v[64:79], a[204:207], a[12:15], v[96:111]
  ds_read_b128 a[140:143], v43 offset:224
  ds_read_b128 a[144:147], v43 offset:128
  buffer_load_dwordx4 v58, s[48:51], s10 offen offset:2048  lds
  s_waitcnt lgkmcnt(9)
  v_mfma_f32_32x32x16_bf16 v[96:111], a[208:211], a[12:15], v[96:111]
  ds_read_b128 a[148:151], v43 offset:160
  ds_read_b128 a[152:155], v43 offset:64
  s_waitcnt lgkmcnt(8)
  v_mfma_f32_16x16x32_bf16 v[44:47], a[160:163], a[4:7], 0
  buffer_load_dwordx4 v59, s[48:51], s10 offen offset:3072  lds
  s_add_u32 m0, s14, 20480
  v_mfma_f32_16x16x32_bf16 v[48:51], a[160:163], a[8:11], 0
  ds_read_b128 a[156:159], v43 offset:96
  s_waitcnt vmcnt(8)
  v_mfma_f32_32x32x16_bf16 v[112:127], v[24:27], a[20:23], v[112:127]
  ds_read_b128 a[168:171], v35 offset:64
  s_waitcnt vmcnt(4)
  buffer_load_dwordx4 v60, s[48:51], s10 offen offset:0  lds
  ds_read_b128 a[172:175], v35 offset:96
  v_mfma_f32_32x32x16_bf16 v[112:127], v[28:31], a[16:19], v[112:127]
  ds_read_b128 a[176:179], v35 offset:128
  v_cvt_pk_bf16_f32 v160, v72, v73
  ds_read_b128 a[180:183], v35 offset:160
  v_cvt_pk_bf16_f32 v161, v74, v75
  buffer_load_dwordx4 v61, s[48:51], s10 offen offset:1024  lds
  v_mfma_f32_32x32x16_bf16 v[112:127], v[28:31], a[20:23], v[112:127]
  ds_read_b128 a[184:187], v35 offset:192
  v_cvt_pk_bf16_f32 v162, v76, v77
  ds_read_b128 a[188:191], v35 offset:224
  v_cvt_pk_bf16_f32 v163, v78, v79
  v_mfma_f32_32x32x16_bf16 v[80:95], a[212:215], a[28:31], v[112:127]
  buffer_load_dwordx4 v62, s[48:51], s10 offen offset:2048  lds
  ds_read_b64_tr_b16 a[32:33], v32 offset:8192
  ds_read_b64_tr_b16 a[34:35], v32 offset:8448
  v_mfma_f32_32x32x16_bf16 v[112:127], a[216:219], a[28:31], v[112:127]
  ds_read_b64_tr_b16 a[36:37], v32 offset:10240
  ds_read_b64_tr_b16 a[38:39], v32 offset:10496
  ds_read_b64_tr_b16 a[48:49], v32 offset:9216
  buffer_load_dwordx4 v63, s[48:51], s10 offen offset:3072  lds
  s_add_u32 m0, s14, 24576
  s_waitcnt lgkmcnt(15)
  v_mfma_f32_16x16x32_bf16 v[44:47], a[164:167], a[20:23], v[44:47]
  ds_read_b64_tr_b16 a[50:51], v32 offset:9472
  ds_read_b64_tr_b16 a[52:53], v32 offset:11264
  v_mfma_f32_16x16x32_bf16 v[48:51], a[164:167], a[24:27], v[48:51]
  ds_read_b64_tr_b16 a[54:55], v32 offset:11520
  buffer_load_dwordx4 v56, s[48:51], s15 offen offset:0  lds
  ds_read_b64_tr_b16 a[44:45], v32 offset:14336
  ds_read_b64_tr_b16 a[46:47], v32 offset:14592
  ds_read_b64_tr_b16 a[40:41], v32 offset:12288
  ds_read_b64_tr_b16 a[42:43], v32 offset:12544
  ds_read_b64_tr_b16 a[60:61], v32 offset:15360
  ds_read_b64_tr_b16 a[62:63], v32 offset:15616
  buffer_load_dwordx4 v57, s[48:51], s15 offen offset:1024  lds
  ds_read_b64_tr_b16 a[56:57], v32 offset:13312
  ds_read_b64_tr_b16 a[58:59], v32 offset:13568
  ds_read_b128 a[220:223], v33 offset:512
  v_cvt_pk_bf16_f32 v192, v96, v97
  ds_read_b128 a[224:227], v34 offset:512
  s_waitcnt lgkmcnt(14)
  v_mfma_f32_16x16x32_bf16 v[44:47], a[168:171], a[36:39], v[44:47]
  buffer_load_dwordx4 v58, s[48:51], s15 offen offset:2048  lds
  v_cvt_pk_bf16_f32 v193, v98, v99
  v_cvt_pk_bf16_f32 v194, v100, v101
  v_cvt_pk_bf16_f32 v195, v102, v103
  v_cvt_pk_bf16_f32 v224, v104, v105
  v_cvt_pk_bf16_f32 v225, v106, v107
  v_cvt_pk_bf16_f32 v226, v108, v109
  v_cvt_pk_bf16_f32 v227, v110, v111
  s_waitcnt lgkmcnt(10)
  v_mfma_f32_16x16x32_bf16 v[44:47], a[172:175], a[52:55], v[44:47]
  buffer_load_dwordx4 v59, s[48:51], s15 offen offset:3072  lds
  s_add_u32 m0, s14, 28672
  ds_read_b128 v[56:59], v53 offset:16
  v_mfma_f32_32x32x16_bf16 v[96:111], v[24:27], a[32:35], 0
  s_waitcnt vmcnt(8)
  ds_read_b64_tr_b16 a[64:65], v32 offset:16384
  ds_read_b64_tr_b16 a[66:67], v32 offset:16640
  ds_read_b64_tr_b16 a[68:69], v32 offset:18432
  s_waitcnt lgkmcnt(10)
  v_mfma_f32_16x16x32_bf16 v[48:51], a[168:171], a[40:43], v[48:51]
  ds_read_b64_tr_b16 a[70:71], v32 offset:18688
  ds_read_b64_tr_b16 a[80:81], v32 offset:17408
  s_waitcnt lgkmcnt(8)
  v_mfma_f32_16x16x32_bf16 v[48:51], a[172:175], a[56:59], v[48:51]
  ds_read_b64_tr_b16 a[82:83], v32 offset:17664
  ds_read_b64_tr_b16 a[84:85], v32 offset:19456
  v_mfma_f32_32x32x16_bf16 v[96:111], v[24:27], a[36:39], v[96:111]
  ds_read_b64_tr_b16 a[86:87], v32 offset:19712
  s_waitcnt vmcnt(4)
  buffer_load_dwordx4 v60, s[48:51], s15 offen offset:0  lds
  ds_read_b64_tr_b16 a[76:77], v32 offset:22528
  v_mfma_f32_32x32x16_bf16 v[96:111], v[28:31], a[32:35], v[96:111]
  ds_read_b64_tr_b16 a[78:79], v32 offset:22784
  ds_read_b64_tr_b16 a[72:73], v32 offset:20480
  ds_read_b64_tr_b16 a[74:75], v32 offset:20736
  ds_read_b64_tr_b16 a[92:93], v32 offset:23552
  buffer_load_dwordx4 v61, s[48:51], s15 offen offset:1024  lds
  s_waitcnt lgkmcnt(13)
  v_xad_u32 v59, v54, s11, v59
  v_xad_u32 v58, v54, s74, v58
  v_mfma_f32_32x32x16_bf16 v[96:111], v[28:31], a[36:39], v[96:111]
  ds_read_b64_tr_b16 a[94:95], v32 offset:23808
  ds_read_b64_tr_b16 a[88:89], v32 offset:21504
  ds_read_b64_tr_b16 a[90:91], v32 offset:21760
  buffer_load_dwordx4 v62, s[48:51], s15 offen offset:2048  lds
  s_waitcnt lgkmcnt(12)
  v_mfma_f32_16x16x32_bf16 v[44:47], a[176:179], a[68:71], v[44:47]
  v_cvt_pk_bf16_f32 v128, v64, v65
  v_cvt_pk_bf16_f32 v129, v66, v67
  v_cvt_pk_bf16_f32 v130, v68, v69
  v_cvt_pk_bf16_f32 v131, v70, v71
  v_mfma_f32_32x32x16_bf16 v[64:79], a[220:223], a[44:47], v[96:111]
  ds_read_b128 a[204:207], v33 offset:768
  buffer_load_dwordx4 v63, s[48:51], s15 offen offset:3072  lds
  s_add_u32 m0, s14, 4096
  ds_read_b128 a[208:211], v34 offset:768
  v_mfma_f32_32x32x16_bf16 v[96:111], a[224:227], a[44:47], v[96:111]
  v_cvt_pk_bf16_f32 v164, v88, v89
  ds_write_b128 v36, v[160:163] offset:16384
  buffer_load_dwordx4 v59, s[36:39], 0 offen offset:3072 nt lds
  s_waitcnt lgkmcnt(7)
  v_mfma_f32_16x16x32_bf16 v[48:51], a[176:179], a[72:75], v[48:51]
  v_cvt_pk_bf16_f32 v165, v90, v91
  v_cvt_pk_bf16_f32 v166, v92, v93
  v_mfma_f32_16x16x32_bf16 v[44:47], a[180:183], a[84:87], v[44:47]
  v_cvt_pk_bf16_f32 v167, v94, v95
  v_cvt_pk_bf16_f32 v196, v112, v113
  s_waitcnt lgkmcnt(3)
  v_mfma_f32_16x16x32_bf16 v[48:51], a[180:183], a[88:91], v[48:51]
  v_cvt_pk_bf16_f32 v197, v114, v115
  v_cvt_pk_bf16_f32 v198, v116, v117
  v_cvt_pk_bf16_f32 v199, v118, v119
  v_cvt_pk_bf16_f32 v228, v120, v121
  v_cvt_pk_bf16_f32 v229, v122, v123
  buffer_load_dwordx4 v58, s[36:39], s54 offen offset:2048 nt lds
  s_add_u32 m0, s14, 8192
  v_cvt_pk_bf16_f32 v230, v124, v125
  v_cvt_pk_bf16_f32 v231, v126, v127
  v_mfma_f32_32x32x16_bf16 v[112:127], v[24:27], a[48:51], 0
  v_cvt_pk_bf16_f32 v132, v80, v81
  v_cvt_pk_bf16_f32 v133, v82, v83
  v_cvt_pk_bf16_f32 v134, v84, v85
  v_cvt_pk_bf16_f32 v135, v86, v87
  ds_read_b128 a[212:215], v33 offset:1024
  v_mfma_f32_32x32x16_bf16 v[112:127], v[24:27], a[52:55], v[112:127]
  ds_read_b128 a[216:219], v34 offset:1024
  v_cvt_pk_bf16_f32 v168, v72, v73
  buffer_load_dwordx4 v0, s[36:39], s52 offen offset:0 nt lds
  v_mfma_f32_32x32x16_bf16 v[112:127], v[28:31], a[48:51], v[112:127]
  ds_write_b128 v36, v[164:167] offset:17408
  v_mfma_f32_32x32x16_bf16 v[112:127], v[28:31], a[52:55], v[112:127]
  v_cvt_pk_bf16_f32 v169, v74, v75
  v_cvt_pk_bf16_f32 v170, v76, v77
  v_cvt_pk_bf16_f32 v171, v78, v79
  v_cvt_pk_bf16_f32 v200, v96, v97
  v_cvt_pk_bf16_f32 v201, v98, v99
  buffer_load_dwordx4 v1, s[36:39], s53 offen offset:1024 nt lds
  s_waitcnt lgkmcnt(5)
  v_mfma_f32_32x32x16_bf16 v[80:95], a[204:207], a[60:63], v[112:127]
  s_waitcnt vmcnt(8)
  ds_read_b64_tr_b16 a[96:97], v32 offset:24576
  ds_read_b64_tr_b16 a[98:99], v32 offset:24832
  ds_read_b64_tr_b16 a[100:101], v32 offset:26624
  s_waitcnt lgkmcnt(7)
  v_mfma_f32_32x32x16_bf16 v[112:127], a[208:211], a[60:63], v[112:127]
  ds_read_b64_tr_b16 a[102:103], v32 offset:26880
  ds_read_b64_tr_b16 a[112:113], v32 offset:25600
  ds_read_b64_tr_b16 a[114:115], v32 offset:25856
  ds_read_b64_tr_b16 a[116:117], v32 offset:27648
  ds_read_b64_tr_b16 a[118:119], v32 offset:27904
  s_waitcnt vmcnt(4)
  s_cmp_ge_u32 s32, 24
  s_cbranch_scc1 L_h00
  s_add_u32 m0, s14, 4096
  v_xad_u32 v57, v54, s73, v57
  buffer_load_dwordx4 v57, s[36:39], s53 offen offset:1024 nt lds
  v_xad_u32 v56, v54, s72, v56
  buffer_load_dwordx4 v56, s[36:39], s52 offen offset:0 nt lds
L_h00:
  s_add_u32 m0, s14, 8192
  v_xad_u32 v2, v54, 64, v2
  v_xad_u32 v3, v54, s55, v3
  buffer_load_dwordx4 v2, s[36:39], s54 offen offset:2048 nt lds
  ds_read_b64_tr_b16 a[108:109], v32 offset:30720
  ds_read_b64_tr_b16 a[110:111], v32 offset:30976
  ds_read_b64_tr_b16 a[104:105], v32 offset:28672
  ds_read_b64_tr_b16 a[106:107], v32 offset:28928
  ds_read_b64_tr_b16 a[124:125], v32 offset:31744
  ds_read_b64_tr_b16 a[126:127], v32 offset:32000
  ds_read_b64_tr_b16 a[120:121], v32 offset:29696
  ds_read_b64_tr_b16 a[122:123], v32 offset:29952
  ds_write_b128 v36, v[192:195] offset:24576
  buffer_load_dwordx4 v3, s[36:39], 0 offen offset:3072 nt lds
  ds_read_b128 v[0:3], v53 offset:144
  s_waitcnt lgkmcnt(14)
  v_mfma_f32_16x16x32_bf16 v[44:47], a[184:187], a[100:103], v[44:47]
  v_cvt_pk_bf16_f32 v202, v100, v101
  v_cvt_pk_bf16_f32 v203, v102, v103
  s_waitcnt lgkmcnt(10)
  v_mfma_f32_16x16x32_bf16 v[44:47], a[188:191], a[116:119], v[44:47]
  v_cvt_pk_bf16_f32 v232, v104, v105
  ds_write_b128 v36, v[196:199] offset:25600
  v_cvt_pk_bf16_f32 v233, v106, v107
  s_cmp_ge_u32 s32, 16
  s_cbranch_scc1 L_h01
  s_add_u32 m0, s14, 0
  v_xad_u32 v7, v54, s55, v7
  buffer_load_dwordx4 v7, s[36:39], 0 offen offset:3072 nt lds
  v_xad_u32 v6, v54, 64, v6
  buffer_load_dwordx4 v6, s[36:39], s54 offen offset:2048 nt lds
L_h01:
  s_add_u32 m0, s14, 12288
  s_waitcnt lgkmcnt(7)
  v_mfma_f32_16x16x32_bf16 v[48:51], a[184:187], a[104:107], v[48:51]
  v_cvt_pk_bf16_f32 v234, v108, v109
  v_cvt_pk_bf16_f32 v235, v110, v111
  v_mfma_f32_32x32x16_bf16 v[96:111], v[24:27], a[64:67], 0
  v_cvt_pk_bf16_f32 v136, v64, v65
  v_cvt_pk_bf16_f32 v137, v66, v67
  v_cvt_pk_bf16_f32 v138, v68, v69
  v_cvt_pk_bf16_f32 v139, v70, v71
  ds_read_b128 a[220:223], v33 offset:1280
  v_mfma_f32_32x32x16_bf16 v[96:111], v[24:27], a[68:71], v[96:111]
  ds_read_b128 a[224:227], v34 offset:1280
  s_waitcnt lgkmcnt(3)
  v_xad_u32 v0, v54, s72, v0
  buffer_load_dwordx4 v0, s[36:39], s52 offen offset:0 nt lds
  v_xad_u32 v1, v54, s73, v1
  v_mfma_f32_32x32x16_bf16 v[96:111], v[28:31], a[64:67], v[96:111]
  v_cvt_pk_bf16_f32 v172, v88, v89
  ds_write_b128 v36, v[168:171] offset:18432
  v_mfma_f32_32x32x16_bf16 v[96:111], v[28:31], a[68:71], v[96:111]
  v_cvt_pk_bf16_f32 v173, v90, v91
  v_cvt_pk_bf16_f32 v174, v92, v93
  v_cvt_pk_bf16_f32 v175, v94, v95
  buffer_load_dwordx4 v1, s[36:39], s53 offen offset:1024 nt lds
  v_mfma_f32_32x32x16_bf16 v[64:79], a[212:215], a[76:79], v[96:111]
  v_cvt_pk_bf16_f32 v204, v112, v113
  v_cvt_pk_bf16_f32 v205, v114, v115
  v_cvt_pk_bf16_f32 v206, v116, v117
  v_cvt_pk_bf16_f32 v207, v118, v119
  v_cvt_pk_bf16_f32 v236, v120, v121
  v_mfma_f32_32x32x16_bf16 v[96:111], a[216:219], a[76:79], v[96:111]
  ds_write_b128 v36, v[200:203] offset:26624
  s_cmp_ge_u32 s32, 8
  s_cbranch_scc1 L_h02
  s_add_u32 m0, s14, 0
  v_xad_u32 v5, v54, 32, v5
  buffer_load_dwordx4 v5, s[36:39], s53 offen offset:1024 nt lds
  v_xad_u32 v4, v54, 0, v4
  buffer_load_dwordx4 v4, s[36:39], s52 offen offset:0 nt lds
L_h02:
  s_add_u32 m0, s14, 12288
  v_xad_u32 v2, v54, s74, v2
  v_xad_u32 v3, v54, s11, v3
  buffer_load_dwordx4 v2, s[36:39], s54 offen offset:2048 nt lds
  v_mfma_f32_16x16x32_bf16 v[48:51], a[188:191], a[120:123], v[48:51]
  v_cvt_pk_bf16_f32 v237, v122, v123
  v_cvt_pk_bf16_f32 v238, v124, v125
  v_cvt_pk_bf16_f32 v239, v126, v127
  v_mfma_f32_32x32x16_bf16 v[112:127], v[24:27], a[80:83], 0
  v_cvt_pk_bf16_f32 v140, v80, v81
  v_cvt_pk_bf16_f32 v141, v82, v83
  v_cvt_pk_bf16_f32 v142, v84, v85
  v_cvt_pk_bf16_f32 v143, v86, v87
  ds_read_b128 a[204:207], v33 offset:1536
  v_mfma_f32_32x32x16_bf16 v[112:127], v[24:27], a[84:87], v[112:127]
  ds_read_b128 a[208:211], v34 offset:1536
  buffer_load_dwordx4 v3, s[36:39], 0 offen offset:3072 nt lds
  v_cvt_pk_bf16_f32 v176, v72, v73
  v_mfma_f32_32x32x16_bf16 v[112:127], v[28:31], a[80:83], v[112:127]
  ds_write_b128 v36, v[172:175] offset:19456
  v_mfma_f32_32x32x16_bf16 v[112:127], v[28:31], a[84:87], v[112:127]
  v_cvt_pk_bf16_f32 v177, v74, v75
  v_cvt_pk_bf16_f32 v178, v76, v77
  v_cvt_pk_bf16_f32 v179, v78, v79
  v_cvt_pk_bf16_f32 v208, v96, v97
  v_cvt_pk_bf16_f32 v209, v98, v99
  s_waitcnt lgkmcnt(6)
  v_mfma_f32_32x32x16_bf16 v[80:95], a[220:223], a[92:95], v[112:127]
  v_cvt_pk_bf16_f32 v210, v100, v101
  v_cvt_pk_bf16_f32 v211, v102, v103
  v_cvt_pk_bf16_f32 v240, v104, v105
  ds_write_b128 v36, v[204:207] offset:27648
  s_waitcnt lgkmcnt(6)
  v_mfma_f32_32x32x16_bf16 v[112:127], a[224:227], a[92:95], v[112:127]
  v_cvt_pk_bf16_f32 v241, v106, v107
  v_cvt_pk_bf16_f32 v242, v108, v109
  v_cvt_pk_bf16_f32 v243, v110, v111
  v_cvt_pk_bf16_f32 v144, v64, v65
  v_cvt_pk_bf16_f32 v145, v66, v67
  v_mfma_f32_32x32x16_bf16 v[96:111], v[24:27], a[96:99], 0
  v_cvt_pk_bf16_f32 v146, v68, v69
  v_cvt_pk_bf16_f32 v147, v70, v71
  ds_read_b128 a[212:215], v33 offset:1792
  v_cvt_pk_bf16_f32 v180, v88, v89
  ds_read_b128 a[216:219], v34 offset:1792
  v_mfma_f32_32x32x16_bf16 v[96:111], v[24:27], a[100:103], v[96:111]
  ds_write_b128 v36, v[176:179] offset:20480
  v_mfma_f32_32x32x16_bf16 v[96:111], v[28:31], a[96:99], v[96:111]
  v_cvt_pk_bf16_f32 v181, v90, v91
  v_cvt_pk_bf16_f32 v182, v92, v93
  v_cvt_pk_bf16_f32 v183, v94, v95
  v_cvt_pk_bf16_f32 v212, v112, v113
  v_cvt_pk_bf16_f32 v213, v114, v115
  v_mfma_f32_32x32x16_bf16 v[96:111], v[28:31], a[100:103], v[96:111]
  v_cvt_pk_bf16_f32 v214, v116, v117
  v_cvt_pk_bf16_f32 v215, v118, v119
  v_cvt_pk_bf16_f32 v244, v120, v121
  ds_write_b128 v36, v[208:211] offset:28672
  s_waitcnt lgkmcnt(7)
  v_mfma_f32_32x32x16_bf16 v[64:79], a[204:207], a[108:111], v[96:111]
  v_cvt_pk_bf16_f32 v245, v122, v123
  v_cvt_pk_bf16_f32 v246, v124, v125
  v_cvt_pk_bf16_f32 v247, v126, v127
  v_cvt_pk_bf16_f32 v148, v80, v81
  v_cvt_pk_bf16_f32 v149, v82, v83
  s_waitcnt lgkmcnt(6)
  v_mfma_f32_32x32x16_bf16 v[96:111], a[208:211], a[108:111], v[96:111]
  v_cvt_pk_bf16_f32 v150, v84, v85
  v_cvt_pk_bf16_f32 v151, v86, v87
  v_lshlrev_b32 v40, 16, v40
  v_mul_f32 v40, s33, v40
  v_sub_f32 v44, v48, v44
  v_sub_f32 v45, v49, v45
  v_mfma_f32_32x32x16_bf16 v[112:127], v[24:27], a[112:115], 0
  v_sub_f32 v46, v50, v46
  v_sub_f32 v47, v51, v47
  v_fma_f32 v44, v44, s33, v40
  v_fma_f32 v45, v45, s33, v40
  v_fma_f32 v46, v46, s33, v40
  v_fma_f32 v47, v47, s33, v40
  v_mfma_f32_32x32x16_bf16 v[112:127], v[24:27], a[116:119], v[112:127]
  v_and_b32 v48, 0xffff0000, v44
  v_and_b32 v49, 0xffff0000, v45
  v_and_b32 v50, 0xffff0000, v46
  v_and_b32 v51, 0xffff0000, v47
  v_sub_f32 v44, v44, v48
  v_sub_f32 v45, v45, v49
  v_mfma_f32_32x32x16_bf16 v[112:127], v[28:31], a[112:115], v[112:127]
  v_sub_f32 v46, v46, v50
  v_sub_f32 v47, v47, v51
  v_cvt_pk_bf16_f32 v60, v48, v44
  v_cvt_pk_bf16_f32 v61, v49, v45
  v_cvt_pk_bf16_f32 v62, v50, v46
  v_cvt_pk_bf16_f32 v63, v51, v47
  v_mfma_f32_32x32x16_bf16 v[112:127], v[28:31], a[116:119], v[112:127]
  ds_write_b128 v41, v[60:63]
  s_waitcnt lgkmcnt(4)
  v_mfma_f32_32x32x16_bf16 v[80:95], a[212:215], a[124:127], v[112:127]
  v_cvt_pk_bf16_f32 v184, v72, v73
  ds_write_b128 v41, v[60:63] offset:2048
  s_waitcnt lgkmcnt(4)
  v_mfma_f32_32x32x16_bf16 v[112:127], a[216:219], a[124:127], v[112:127]
  v_cvt_pk_bf16_f32 v185, v74, v75
  ds_write_b128 v36, v[180:183] offset:21504
  v_cvt_pk_bf16_f32 v186, v76, v77
  v_cvt_pk_bf16_f32 v187, v78, v79
  v_cvt_pk_bf16_f32 v216, v96, v97
  v_cvt_pk_bf16_f32 v217, v98, v99
  v_cvt_pk_bf16_f32 v218, v100, v101
  v_cvt_pk_bf16_f32 v219, v102, v103
  v_cvt_pk_bf16_f32 v248, v104, v105
  ds_write_b128 v36, v[212:215] offset:29696
  v_cvt_pk_bf16_f32 v249, v106, v107
  v_cvt_pk_bf16_f32 v250, v108, v109
  v_cvt_pk_bf16_f32 v251, v110, v111
  v_cvt_pk_bf16_f32 v152, v64, v65
  v_cvt_pk_bf16_f32 v153, v66, v67
  v_cvt_pk_bf16_f32 v154, v68, v69
  v_cvt_pk_bf16_f32 v155, v70, v71
  ds_write_b128 v36, v[184:187] offset:22528
  s_waitcnt vmcnt(8)
  s_cmp_ge_u32 s32, 24
  s_cbranch_scc1 L_h0w
  s_waitcnt vmcnt(6)
  s_cmp_ge_u32 s32, 16
  s_cbranch_scc1 L_h0w
  s_waitcnt vmcnt(2)
L_h0w:
  ds_write_b128 v36, v[216:219] offset:30720
  v_bfe_u32 v0, v8, 8, 5
  v_cmp_gt_u32 vcc, s32, v0
  v_cvt_pk_bf16_f32 v188, v88, v89
  v_cvt_pk_bf16_f32 v189, v90, v91
  v_cndmask_b32 v0, 0, 1, vcc
  v_lshl_or_b32 v1, v0, 20, v8
  ds_read_b128 a[0:3], v1 offset:0
  v_lshl_or_b32 v2, v0, 20, v9
  ds_read_b128 a[4:7], v2 offset:0
  v_lshl_or_b32 v3, v0, 20, v10
  ds_read_b128 a[8:11], v3 offset:0
  v_lshl_or_b32 v4, v0, 20, v11
  ds_read_b128 a[12:15], v4 offset:0
  v_lshl_or_b32 v5, v0, 20, v12
  ds_read_b128 a[16:19], v5 offset:0
  v_lshl_or_b32 v6, v0, 20, v13
  ds_read_b128 a[20:23], v6 offset:0
  v_lshl_or_b32 v7, v0, 20, v14
  ds_read_b128 a[24:27], v7 offset:0
  v_lshl_or_b32 v1, v0, 20, v15
  ds_read_b128 a[28:31], v1 offset:0
  v_cvt_pk_bf16_f32 v190, v92, v93
  v_cvt_pk_bf16_f32 v191, v94, v95
  ds_write_b128 v36, v[188:191] offset:23552
  v_cvt_pk_bf16_f32 v220, v112, v113
  v_cvt_pk_bf16_f32 v221, v114, v115
  v_cvt_pk_bf16_f32 v222, v116, v117
  v_cvt_pk_bf16_f32 v223, v118, v119
  ds_write_b128 v36, v[220:223] offset:31744
  s_waitcnt lgkmcnt(9)
  v_mfma_f32_32x32x16_bf16 v[64:79], v[128:131], a[0:3], 0
  v_cvt_pk_bf16_f32 v252, v120, v121
  v_cvt_pk_bf16_f32 v253, v122, v123
  v_cvt_pk_bf16_f32 v254, v124, v125
  v_cvt_pk_bf16_f32 v255, v126, v127
  v_cvt_pk_bf16_f32 v156, v80, v81
  s_waitcnt lgkmcnt(8)
  v_mfma_f32_32x32x16_bf16 v[64:79], v[132:135], a[4:7], v[64:79]
  v_cvt_pk_bf16_f32 v157, v82, v83
  v_cvt_pk_bf16_f32 v158, v84, v85
  v_cvt_pk_bf16_f32 v159, v86, v87
  v_lshlrev_b32 v28, 16, v42
  v_lshlrev_b32 v29, 16, v42
  v_lshlrev_b32 v30, 16, v42
  s_waitcnt lgkmcnt(7)
  v_mfma_f32_32x32x16_bf16 v[64:79], v[136:139], a[8:11], v[64:79]
  v_lshlrev_b32 v31, 16, v42
  s_add_u32 m0, s14, 16384
  s_waitcnt lgkmcnt(0)
  s_nop 0
  s_barrier
  ds_read_b128 v[160:163], v37 offset:16384
  v_mfma_f32_32x32x16_bf16 v[64:79], v[140:143], a[12:15], v[64:79]
  ds_read_b128 v[164:167], v37 offset:17408
  ds_read_b128 v[168:171], v37 offset:18432
  v_mfma_f32_32x32x16_bf16 v[64:79], v[144:147], a[16:19], v[64:79]
  ds_read_b128 v[172:175], v37 offset:19456
  ds_read_b128 v[176:179], v37 offset:20480
  v_mfma_f32_32x32x16_bf16 v[64:79], v[148:151], a[20:23], v[64:79]
  ds_read_b128 v[180:183], v37 offset:21504
  ds_read_b128 v[184:187], v37 offset:22528
  v_mfma_f32_32x32x16_bf16 v[64:79], v[152:155], a[24:27], v[64:79]
  ds_read_b128 v[188:191], v37 offset:23552
  ds_read_b32 v61, v41 offset:1540
  ds_read_b32 v62, v41 offset:1032
  v_mfma_f32_32x32x16_bf16 v[64:79], v[156:159], a[28:31], v[64:79]
  ds_read_b32 v63, v41 offset:524
  ds_read_b128 v[192:195], v38 offset:24576
  ds_read_b128 v[196:199], v38 offset:25600
  s_waitcnt lgkmcnt(12)
  v_mfma_f32_32x32x16_bf16 v[80:95], v[160:163], a[0:3], 0
  ds_read_b128 v[200:203], v38 offset:26624
  ds_read_b128 v[204:207], v38 offset:27648
  s_waitcnt lgkmcnt(13)
  v_mfma_f32_32x32x16_bf16 v[80:95], v[164:167], a[4:7], v[80:95]
  ds_read_b128 v[208:211], v38 offset:28672
  ds_read_b128 v[212:215], v38 offset:29696
  s_waitcnt lgkmcnt(14)
  v_mfma_f32_32x32x16_bf16 v[80:95], v[168:171], a[8:11], v[80:95]
  ds_read_b128 v[216:219], v38 offset:30720
  ds_read_b128 v[220:223], v38 offset:31744
  s_waitcnt lgkmcnt(15)
  v_mfma_f32_32x32x16_bf16 v[80:95], v[172:175], a[12:15], v[80:95]
  ds_read_b64_tr_b16 a[64:65], v16 offset:0
  ds_read_b64_tr_b16 a[66:67], v16 offset:512
  ds_read_b64_tr_b16 a[68:69], v17 offset:0
  ds_read_b64_tr_b16 a[70:71], v17 offset:512
  s_waitcnt lgkmcnt(15)
  v_mfma_f32_32x32x16_bf16 v[80:95], v[176:179], a[16:19], v[80:95]
  ds_read_b64_tr_b16 a[72:73], v18 offset:0
  ds_read_b64_tr_b16 a[74:75], v18 offset:512
  s_nop 0
  s_waitcnt lgkmcnt(14)
  v_mfma_f32_32x32x16_bf16 v[64:79], v[60:63], a[196:199], v[64:79]
  s_waitcnt lgkmcnt(6)
  s_barrier
  v_mfma_f32_32x32x16_bf16 v[80:95], v[180:183], a[20:23], v[80:95]
  ds_write_b128 v36, v[224:227] offset:24576
  v_mfma_f32_32x32x16_bf16 v[80:95], v[184:187], a[24:27], v[80:95]
  ds_write_b128 v36, v[228:231] offset:25600
  v_mfma_f32_32x32x16_bf16 v[80:95], v[188:191], a[28:31], v[80:95]
  ds_read_b128 v[0:3], v53 offset:256
  ds_write_b128 v36, v[232:235] offset:26624
  v_mfma_f32_32x32x16_bf16 v[80:95], v[60:63], a[200:203], v[80:95]
  ds_write_b128 v36, v[236:239] offset:27648
  v_mfma_f32_32x32x16_bf16 v[96:111], v[192:195], a[0:3], 0
  v_exp_f32 v64, v64
  v_exp_f32 v65, v65
  v_exp_f32 v66, v66
  v_mfma_f32_32x32x16_bf16 v[96:111], v[196:199], a[4:7], v[96:111]
  v_exp_f32 v67, v67
  v_exp_f32 v68, v68
  v_exp_f32 v69, v69
  v_mfma_f32_32x32x16_bf16 v[96:111], v[200:203], a[8:11], v[96:111]
  v_exp_f32 v70, v70
  ds_write_b128 v36, v[240:243] offset:28672
  v_mfma_f32_32x32x16_bf16 v[96:111], v[204:207], a[12:15], v[96:111]
  v_exp_f32 v71, v71
  v_exp_f32 v72, v72
  ds_write_b128 v36, v[244:247] offset:29696
  v_mfma_f32_32x32x16_bf16 v[96:111], v[208:211], a[16:19], v[96:111]
  v_exp_f32 v73, v73
  v_exp_f32 v74, v74
  ds_write_b128 v36, v[248:251] offset:30720
  v_mfma_f32_32x32x16_bf16 v[96:111], v[212:215], a[20:23], v[96:111]
  v_exp_f32 v75, v75
  v_exp_f32 v76, v76
  ds_write_b128 v36, v[252:255] offset:31744
  v_mfma_f32_32x32x16_bf16 v[96:111], v[216:219], a[24:27], v[96:111]
  v_exp_f32 v77, v77
  ds_read_b64_tr_b16 a[76:77], v19 offset:0
  s_waitcnt lgkmcnt(7)
  v_xad_u32 v0, v54, 0, v0
  buffer_load_dwordx4 v0, s[36:39], s52 offen offset:0 nt lds
  v_mfma_f32_32x32x16_bf16 v[96:111], v[220:223], a[28:31], v[96:111]
  ds_read_b64_tr_b16 a[78:79], v19 offset:512
  v_exp_f32 v78, v78
  v_exp_f32 v79, v79
  ds_read_b64_tr_b16 a[80:81], v20 offset:0
  v_mfma_f32_32x32x16_bf16 v[96:111], v[60:63], a[194:197], v[96:111]
  v_xad_u32 v1, v54, 32, v1
  ds_read_b64_tr_b16 a[82:83], v20 offset:512
  v_xad_u32 v2, v54, 64, v2
  ds_read_b64_tr_b16 a[84:85], v21 offset:0
  v_mfma_f32_32x32x16_bf16 v[64:79], a[192:195], a[196:199], v[64:79]
  buffer_load_dwordx4 v1, s[36:39], s53 offen offset:1024 nt lds
  v_xad_u32 v3, v54, s55, v3
  v_exp_f32 v80, v80
  v_exp_f32 v81, v81
  v_exp_f32 v82, v82
  v_exp_f32 v83, v83
  v_exp_f32 v84, v84
  v_exp_f32 v85, v85
  v_exp_f32 v86, v86
  v_exp_f32 v87, v87
  buffer_load_dwordx4 v2, s[36:39], s54 offen offset:2048 nt lds
  v_exp_f32 v88, v88
  v_rcp_f32 v64, v64
  v_rcp_f32 v65, v65
  v_rcp_f32 v66, v66
  v_rcp_f32 v67, v67
  v_cvt_pk_bf16_f32 v44, v64, v65
  v_rcp_f32 v68, v68
  v_rcp_f32 v69, v69
  v_cvt_pk_bf16_f32 v45, v66, v67
  v_rcp_f32 v70, v70
  buffer_load_dwordx4 v3, s[36:39], 0 offen offset:3072 nt lds
  s_waitcnt lgkmcnt(5)
  s_nop 0
  s_barrier
  ds_read_b128 v[224:227], v39 offset:24576
  v_cvt_pk_bf16_f32 v46, v68, v69
  ds_read_b128 v[4:7], v53 offset:272
  v_rcp_f32 v71, v71
  ds_read_b128 v[228:231], v39 offset:25600
  v_rcp_f32 v72, v72
  ds_read_b128 v[232:235], v39 offset:26624
  v_cvt_pk_bf16_f32 v47, v70, v71
  ds_read_b128 v[236:239], v39 offset:27648
  s_add_u32 m0, s14, 20480
  v_mfma_f32_16x16x32_bf16 v[32:35], v[44:47], a[128:131], v[28:31]
  ds_read_b128 v[240:243], v39 offset:28672
  v_rcp_f32 v73, v73
  ds_read_b128 v[244:247], v39 offset:29696
  v_rcp_f32 v74, v74
  v_cvt_pk_bf16_f32 v48, v72, v73
  v_rcp_f32 v75, v75
  v_rcp_f32 v76, v76
  ds_read_b128 v[248:251], v39 offset:30720
  v_cvt_pk_bf16_f32 v49, v74, v75
  v_rcp_f32 v77, v77
  v_rcp_f32 v78, v78
  v_rcp_f32 v79, v79
  s_waitcnt lgkmcnt(7)
  v_mfma_f32_32x32x16_bf16 v[112:127], v[224:227], a[0:3], 0
  v_cvt_pk_bf16_f32 v50, v76, v77
  s_waitcnt lgkmcnt(6)
  v_xad_u32 v4, v54, s72, v4
  buffer_load_dwordx4 v4, s[36:39], s52 offen offset:0 nt lds
  ds_read_b128 v[252:255], v39 offset:31744
  s_waitcnt lgkmcnt(6)
  v_mfma_f32_32x32x16_bf16 v[112:127], v[228:231], a[4:7], v[112:127]
  v_cvt_pk_bf16_f32 v51, v78, v79
  v_xad_u32 v5, v54, s73, v5
  ds_read_b64_tr_b16 a[86:87], v21 offset:512
  ds_read_b64_tr_b16 a[88:89], v22 offset:0
  v_mfma_f32_16x16x32_bf16 v[32:35], v[48:51], a[132:135], v[32:35]
  ds_read_b64_tr_b16 a[90:91], v22 offset:512
  v_exp_f32 v89, v89
  s_waitcnt lgkmcnt(8)
  v_mfma_f32_32x32x16_bf16 v[112:127], v[232:235], a[8:11], v[112:127]
  buffer_load_dwordx4 v5, s[36:39], s53 offen offset:1024 nt lds
  v_exp_f32 v90, v90
  v_exp_f32 v91, v91
  s_waitcnt lgkmcnt(7)
  v_mfma_f32_32x32x16_bf16 v[112:127], v[236:239], a[12:15], v[112:127]
  ds_read_b64_tr_b16 a[92:93], v23 offset:0
  v_xad_u32 v6, v54, s74, v6
  v_exp_f32 v92, v92
  v_exp_f32 v93, v93
  s_waitcnt lgkmcnt(7)
  v_mfma_f32_32x32x16_bf16 v[112:127], v[240:243], a[16:19], v[112:127]
  ds_read_b64_tr_b16 a[94:95], v23 offset:512
  v_exp_f32 v94, v94
  buffer_load_dwordx4 v6, s[36:39], s54 offen offset:2048 nt lds
  s_waitcnt lgkmcnt(7)
  v_mfma_f32_32x32x16_bf16 v[112:127], v[244:247], a[20:23], v[112:127]
  v_exp_f32 v95, v95
  v_xad_u32 v7, v54, s11, v7
  v_exp_f32 v96, v96
  v_exp_f32 v97, v97
  v_mfma_f32_32x32x16_bf16 v[80:95], a[192:195], a[196:199], v[80:95]
  v_exp_f32 v98, v98
  v_exp_f32 v99, v99
  v_exp_f32 v100, v100
  s_waitcnt lgkmcnt(6)
  v_mfma_f32_32x32x16_bf16 v[112:127], v[248:251], a[24:27], v[112:127]
  buffer_load_dwordx4 v7, s[36:39], 0 offen offset:3072 nt lds
  s_nop 0
  s_waitcnt lgkmcnt(5)
  s_barrier
  s_waitcnt vmcnt(8)
  v_mfma_f32_32x32x16_bf16 v[112:127], v[252:255], a[28:31], v[112:127]
  ds_read_b128 a[32:35], v8 offset:8192
  s_add_u32 m0, s14, 24576
  v_exp_f32 v101, v101
  v_rcp_f32 v80, v80
  v_mfma_f32_32x32x16_bf16 v[112:127], v[60:63], a[198:201], v[112:127]
  v_rcp_f32 v81, v81
  ds_read_b128 v[0:3], v53 offset:384
  v_rcp_f32 v82, v82
  v_cvt_pk_bf16_f32 v44, v80, v81
  ds_read_b128 a[36:39], v9 offset:8192
  v_rcp_f32 v83, v83
  v_rcp_f32 v84, v84
  v_rcp_f32 v85, v85
  v_cvt_pk_bf16_f32 v45, v82, v83
  ds_read_b128 a[40:43], v10 offset:8192
  v_rcp_f32 v86, v86
  v_cvt_pk_bf16_f32 v46, v84, v85
  v_rcp_f32 v87, v87
  v_rcp_f32 v88, v88
  ds_read_b128 a[44:47], v11 offset:8192
  v_cvt_pk_bf16_f32 v47, v86, v87
  v_rcp_f32 v89, v89
  ds_read_b128 a[48:51], v12 offset:8192
  v_mfma_f32_16x16x32_bf16 v[32:35], v[44:47], a[136:139], v[32:35]
  v_cvt_pk_bf16_f32 v48, v88, v89
  v_rcp_f32 v90, v90
  s_waitcnt lgkmcnt(5)
  v_mfma_f32_32x32x16_bf16 v[64:79], v[128:131], a[32:35], 0
  v_rcp_f32 v91, v91
  v_rcp_f32 v92, v92
  s_waitcnt lgkmcnt(4)
  v_xad_u32 v0, v54, 0, v0
  buffer_load_dwordx4 v0, s[36:39], s52 offen offset:0 nt lds
  s_waitcnt lgkmcnt(3)
  v_mfma_f32_32x32x16_bf16 v[64:79], v[132:135], a[36:39], v[64:79]
  v_cvt_pk_bf16_f32 v49, v90, v91
  v_rcp_f32 v93, v93
  ds_read_b128 a[52:55], v13 offset:8192
  v_rcp_f32 v94, v94
  s_waitcnt lgkmcnt(3)
  v_mfma_f32_32x32x16_bf16 v[64:79], v[136:139], a[40:43], v[64:79]
  v_cvt_pk_bf16_f32 v50, v92, v93
  v_rcp_f32 v95, v95
  ds_read_b128 a[56:59], v14 offset:8192
  v_xad_u32 v1, v54, 32, v1
  buffer_load_dwordx4 v1, s[36:39], s53 offen offset:1024 nt lds
  s_waitcnt lgkmcnt(3)
  v_mfma_f32_32x32x16_bf16 v[64:79], v[140:143], a[44:47], v[64:79]
  v_cvt_pk_bf16_f32 v51, v94, v95
  ds_read_b128 a[60:63], v15 offset:8192
  v_exp_f32 v102, v102
  v_exp_f32 v103, v103
  v_mfma_f32_16x16x32_bf16 v[32:35], v[48:51], a[140:143], v[32:35]
  ds_read_b128 v[36:39], v52 offset:4096
  v_exp_f32 v104, v104
  s_waitcnt lgkmcnt(4)
  v_mfma_f32_32x32x16_bf16 v[64:79], v[144:147], a[48:51], v[64:79]
  v_exp_f32 v105, v105
  v_exp_f32 v106, v106
  v_exp_f32 v107, v107
  v_mfma_f32_32x32x16_bf16 v[80:95], v[160:163], a[32:35], 0
  v_exp_f32 v108, v108
  v_exp_f32 v109, v109
  v_exp_f32 v110, v110
  s_waitcnt lgkmcnt(3)
  v_mfma_f32_32x32x16_bf16 v[64:79], v[148:151], a[52:55], v[64:79]
  v_exp_f32 v111, v111
  ds_read_b64_tr_b16 a[96:97], v16 offset:8192
  v_xad_u32 v2, v54, 64, v2
  buffer_load_dwordx4 v2, s[36:39], s54 offen offset:2048 nt lds
  v_mfma_f32_32x32x16_bf16 v[96:111], a[192:195], a[196:199], v[96:111]
  ds_read_b64_tr_b16 a[98:99], v16 offset:8704
  ds_read_b64_tr_b16 a[100:101], v17 offset:8192
  ds_read_b64_tr_b16 a[102:103], v17 offset:8704
  v_xad_u32 v3, v54, s55, v3
  s_waitcnt lgkmcnt(6)
  v_mfma_f32_32x32x16_bf16 v[64:79], v[152:155], a[56:59], v[64:79]
  ds_read_b64_tr_b16 a[104:105], v18 offset:8192
  ds_read_b64_tr_b16 a[106:107], v18 offset:8704
  v_exp_f32 v112, v112
  v_exp_f32 v113, v113
  s_waitcnt lgkmcnt(7)
  v_mfma_f32_32x32x16_bf16 v[64:79], v[156:159], a[60:63], v[64:79]
  buffer_load_dwordx4 v3, s[36:39], 0 offen offset:3072 nt lds
  v_exp_f32 v114, v114
  v_rcp_f32 v96, v96
  v_mfma_f32_32x32x16_bf16 v[64:79], v[60:63], a[196:199], v[64:79]
  v_rcp_f32 v97, v97
  v_rcp_f32 v98, v98
  v_rcp_f32 v99, v99
  v_mfma_f32_32x32x16_bf16 v[80:95], v[164:167], a[36:39], v[80:95]
  v_cvt_pk_bf16_f32 v44, v96, v97
  v_rcp_f32 v100, v100
  v_cvt_pk_bf16_f32 v45, v98, v99
  v_rcp_f32 v101, v101
  v_mfma_f32_32x32x16_bf16 v[80:95], v[168:171], a[40:43], v[80:95]
  v_rcp_f32 v102, v102
  v_cvt_pk_bf16_f32 v46, v100, v101
  v_rcp_f32 v103, v103
  v_rcp_f32 v104, v104
  v_mfma_f32_32x32x16_bf16 v[80:95], v[172:175], a[44:47], v[80:95]
  v_cvt_pk_bf16_f32 v47, v102, v103
  v_rcp_f32 v105, v105
  v_rcp_f32 v106, v106
  v_rcp_f32 v107, v107
  v_mfma_f32_16x16x32_bf16 v[32:35], v[44:47], a[144:147], v[32:35]
  v_cvt_pk_bf16_f32 v48, v104, v105
  v_rcp_f32 v108, v108
  v_mfma_f32_32x32x16_bf16 v[80:95], v[176:179], a[48:51], v[80:95]
  v_cvt_pk_bf16_f32 v49, v106, v107
  v_rcp_f32 v109, v109
  v_rcp_f32 v110, v110
  v_rcp_f32 v111, v111
  v_mfma_f32_32x32x16_bf16 v[80:95], v[180:183], a[52:55], v[80:95]
  v_cvt_pk_bf16_f32 v50, v108, v109
  v_exp_f32 v115, v115
  v_cvt_pk_bf16_f32 v51, v110, v111
  v_exp_f32 v116, v116
  v_mfma_f32_32x32x16_bf16 v[80:95], v[184:187], a[56:59], v[80:95]
  v_exp_f32 v117, v117
  v_exp_f32 v118, v118
  v_exp_f32 v119, v119
  v_mfma_f32_16x16x32_bf16 v[32:35], v[48:51], a[148:151], v[32:35]
  v_exp_f32 v120, v120
  v_mfma_f32_32x32x16_bf16 v[80:95], v[188:191], a[60:63], v[80:95]
  v_exp_f32 v121, v121
  v_exp_f32 v122, v122
  v_exp_f32 v123, v123
  v_mfma_f32_32x32x16_bf16 v[80:95], v[60:63], a[200:203], v[80:95]
  v_exp_f32 v124, v124
  v_exp_f32 v125, v125
  v_exp_f32 v126, v126
  v_mfma_f32_32x32x16_bf16 v[96:111], v[192:195], a[32:35], 0
  v_exp_f32 v127, v127
  ds_read_b64_tr_b16 a[108:109], v19 offset:8192
  ds_read_b128 v[4:7], v53 offset:400
  s_add_u32 m0, s14, 28672
  v_mfma_f32_32x32x16_bf16 v[96:111], v[196:199], a[36:39], v[96:111]
  ds_read_b64_tr_b16 a[110:111], v19 offset:8704
  ds_read_b64_tr_b16 a[112:113], v20 offset:8192
  ds_read_b64_tr_b16 a[114:115], v20 offset:8704
  ds_read_b64_tr_b16 a[116:117], v21 offset:8192
  v_mfma_f32_32x32x16_bf16 v[112:127], a[192:195], a[196:199], v[112:127]
  v_exp_f32 v64, v64
  v_exp_f32 v65, v65
  v_exp_f32 v66, v66
  v_mfma_f32_32x32x16_bf16 v[96:111], v[200:203], a[40:43], v[96:111]
  v_exp_f32 v67, v67
  v_exp_f32 v68, v68
  v_exp_f32 v69, v69
  v_mfma_f32_32x32x16_bf16 v[96:111], v[204:207], a[44:47], v[96:111]
  v_exp_f32 v70, v70
  v_exp_f32 v71, v71
  v_exp_f32 v72, v72
  v_mfma_f32_32x32x16_bf16 v[96:111], v[208:211], a[48:51], v[96:111]
  v_rcp_f32 v112, v112
  v_rcp_f32 v113, v113
  v_rcp_f32 v114, v114
  v_mfma_f32_32x32x16_bf16 v[96:111], v[212:215], a[52:55], v[96:111]
  v_cvt_pk_bf16_f32 v44, v112, v113
  v_rcp_f32 v115, v115
  v_rcp_f32 v116, v116
  v_rcp_f32 v117, v117
  v_mfma_f32_32x32x16_bf16 v[96:111], v[216:219], a[56:59], v[96:111]
  v_cvt_pk_bf16_f32 v45, v114, v115
  v_rcp_f32 v118, v118
  v_cvt_pk_bf16_f32 v46, v116, v117
  v_rcp_f32 v119, v119
  v_mfma_f32_32x32x16_bf16 v[96:111], v[220:223], a[60:63], v[96:111]
  v_rcp_f32 v120, v120
  v_cvt_pk_bf16_f32 v47, v118, v119
  s_waitcnt lgkmcnt(4)
  v_xad_u32 v4, v54, s72, v4
  buffer_load_dwordx4 v4, s[36:39], s52 offen offset:0 nt lds
  v_mfma_f32_16x16x32_bf16 v[32:35], v[44:47], a[152:155], v[32:35]
  v_rcp_f32 v121, v121
  v_mfma_f32_32x32x16_bf16 v[96:111], v[60:63], a[194:197], v[96:111]
  v_rcp_f32 v122, v122
  v_cvt_pk_bf16_f32 v48, v120, v121
  v_rcp_f32 v123, v123
  v_rcp_f32 v124, v124
  v_rcp_f32 v125, v125
  v_cvt_pk_bf16_f32 v49, v122, v123
  v_rcp_f32 v126, v126
  v_rcp_f32 v127, v127
  v_cvt_pk_bf16_f32 v50, v124, v125
  v_xad_u32 v5, v54, s73, v5
  buffer_load_dwordx4 v5, s[36:39], s53 offen offset:1024 nt lds
  v_cvt_pk_bf16_f32 v51, v126, v127
  v_exp_f32 v73, v73
  v_exp_f32 v74, v74
  v_mfma_f32_16x16x32_bf16 v[32:35], v[48:51], a[156:159], v[32:35]
  v_exp_f32 v75, v75
  v_exp_f32 v76, v76
  v_exp_f32 v77, v77
  v_exp_f32 v78, v78
  v_exp_f32 v79, v79
  ds_read_b64_tr_b16 a[118:119], v21 offset:8704
  v_xad_u32 v6, v54, s74, v6
  buffer_load_dwordx4 v6, s[36:39], s54 offen offset:2048 nt lds
  v_mfma_f32_32x32x16_bf16 v[64:79], a[192:195], a[196:199], v[64:79]
  v_mul_legacy_f32 v32, v32, v36
  v_mul_legacy_f32 v33, v33, v37
  v_mul_legacy_f32 v34, v34, v38
  v_mul_legacy_f32 v35, v35, v39
  v_cvt_pk_bf16_f32 v40, v32, v33
  v_cvt_pk_bf16_f32 v41, v34, v35
  ds_read_b64_tr_b16 a[120:121], v22 offset:8192
  v_mov_b32_dpp v42, v40 quad_perm:[1,0,3,2] row_mask:0xf bank_mask:0xf
  v_mov_b32_dpp v43, v41 quad_perm:[1,0,3,2] row_mask:0xf bank_mask:0xf
  ds_read_b64_tr_b16 a[122:123], v22 offset:8704
  ds_read_b64_tr_b16 a[124:125], v23 offset:8192
  v_mfma_f32_16x16x32_bf16 a[160:163], v[40:43], a[64:67], 0
  v_rcp_f32 v64, v64
  v_mfma_f32_16x16x32_bf16 a[176:179], v[40:43], a[80:83], 0
  v_rcp_f32 v65, v65
  v_mfma_f32_16x16x32_bf16 a[164:167], v[40:43], a[68:71], 0
  v_rcp_f32 v66, v66
  v_mfma_f32_16x16x32_bf16 a[180:183], v[40:43], a[84:87], 0
  v_cvt_pk_bf16_f32 v44, v64, v65
  v_rcp_f32 v67, v67
  v_mfma_f32_16x16x32_bf16 a[168:171], v[40:43], a[72:75], 0
  v_rcp_f32 v68, v68
  v_mfma_f32_16x16x32_bf16 a[184:187], v[40:43], a[88:91], 0
  v_cvt_pk_bf16_f32 v45, v66, v67
  v_rcp_f32 v69, v69
  v_mfma_f32_16x16x32_bf16 a[172:175], v[40:43], a[76:79], 0
  v_rcp_f32 v70, v70
  v_mfma_f32_16x16x32_bf16 a[188:191], v[40:43], a[92:95], 0
  v_cvt_pk_bf16_f32 v46, v68, v69
  v_rcp_f32 v71, v71
  v_rcp_f32 v72, v72
  v_xad_u32 v7, v54, s11, v7
  buffer_load_dwordx4 v7, s[36:39], 0 offen offset:3072 nt lds
  v_cvt_pk_bf16_f32 v47, v70, v71
  v_rcp_f32 v73, v73
  ds_read_b64_tr_b16 a[126:127], v23 offset:8704
  v_mfma_f32_16x16x32_bf16 v[32:35], v[44:47], a[128:131], v[28:31]
  v_cvt_pk_bf16_f32 v48, v72, v73
  v_rcp_f32 v74, v74
  v_rcp_f32 v75, v75
  v_rcp_f32 v76, v76
  v_rcp_f32 v77, v77
  v_cvt_pk_bf16_f32 v49, v74, v75
  v_rcp_f32 v78, v78
  v_rcp_f32 v79, v79
  v_cvt_pk_bf16_f32 v50, v76, v77
  v_exp_f32 v80, v80
  v_exp_f32 v81, v81
  v_cvt_pk_bf16_f32 v51, v78, v79
  v_exp_f32 v82, v82
  v_exp_f32 v83, v83
  v_mfma_f32_16x16x32_bf16 v[32:35], v[48:51], a[132:135], v[32:35]
  v_exp_f32 v84, v84
  v_exp_f32 v85, v85
  v_exp_f32 v86, v86
  v_exp_f32 v87, v87
  v_exp_f32 v88, v88
  v_exp_f32 v89, v89
  v_exp_f32 v90, v90
  v_exp_f32 v91, v91
  v_exp_f32 v92, v92
  v_exp_f32 v93, v93
  v_exp_f32 v94, v94
  v_exp_f32 v95, v95
  s_nop 2
  v_mfma_f32_32x32x16_bf16 v[80:95], a[192:195], a[196:199], v[80:95]
  s_waitcnt lgkmcnt(0)
  s_cmp_gt_u32 s13, 128
  s_cbranch_scc1 L_wrap
L_tail:
  v_mfma_f32_32x32x16_bf16 v[112:127], v[224:227], a[32:35], 0
  s_waitcnt vmcnt(8)
  ds_read_b128 a[0:3], v8 offset:16384
  s_nop 5
  v_rcp_f32 v80, v80
  v_rcp_f32 v81, v81
  v_mfma_f32_32x32x16_bf16 v[112:127], v[228:231], a[36:39], v[112:127]
  v_rcp_f32 v82, v82
  v_cvt_pk_bf16_f32 v44, v80, v81
  ds_read_b128 a[4:7], v9 offset:16384
  v_rcp_f32 v83, v83
  v_mfma_f32_32x32x16_bf16 v[112:127], v[232:235], a[40:43], v[112:127]
  v_rcp_f32 v84, v84
  v_cvt_pk_bf16_f32 v45, v82, v83
  v_rcp_f32 v85, v85
  ds_read_b128 a[8:11], v10 offset:16384
  v_mfma_f32_32x32x16_bf16 v[112:127], v[236:239], a[44:47], v[112:127]
  v_cvt_pk_bf16_f32 v46, v84, v85
  v_rcp_f32 v86, v86
  v_rcp_f32 v87, v87
  ds_read_b128 a[12:15], v11 offset:16384
  v_mfma_f32_32x32x16_bf16 v[112:127], v[240:243], a[48:51], v[112:127]
  v_cvt_pk_bf16_f32 v47, v86, v87
  v_rcp_f32 v88, v88
  v_rcp_f32 v89, v89
  ds_read_b128 a[16:19], v12 offset:16384
  v_mfma_f32_16x16x32_bf16 v[32:35], v[44:47], a[136:139], v[32:35]
  v_cvt_pk_bf16_f32 v48, v88, v89
  v_rcp_f32 v90, v90
  v_mfma_f32_32x32x16_bf16 v[112:127], v[244:247], a[52:55], v[112:127]
  v_rcp_f32 v91, v91
  v_rcp_f32 v92, v92
  ds_read_b128 a[20:23], v13 offset:16384
  v_cvt_pk_bf16_f32 v49, v90, v91
  v_mfma_f32_32x32x16_bf16 v[112:127], v[248:251], a[56:59], v[112:127]
  v_rcp_f32 v93, v93
  v_rcp_f32 v94, v94
  v_rcp_f32 v95, v95
  v_mfma_f32_32x32x16_bf16 v[112:127], v[252:255], a[60:63], v[112:127]
  v_cvt_pk_bf16_f32 v50, v92, v93
  ds_read_b128 a[24:27], v14 offset:16384
  v_cvt_pk_bf16_f32 v51, v94, v95
  v_exp_f32 v96, v96
  v_mfma_f32_32x32x16_bf16 v[112:127], v[60:63], a[198:201], v[112:127]
  v_exp_f32 v97, v97
  ds_read_b128 a[28:31], v15 offset:16384
  v_exp_f32 v98, v98
  v_exp_f32 v99, v99
  v_mfma_f32_16x16x32_bf16 v[32:35], v[48:51], a[140:143], v[32:35]
  v_exp_f32 v100, v100
  s_waitcnt lgkmcnt(7)
  v_mfma_f32_32x32x16_bf16 v[64:79], v[128:131], a[0:3], 0
  v_exp_f32 v101, v101
  ds_read_b128 v[36:39], v52 offset:4224
  v_exp_f32 v102, v102
  v_exp_f32 v103, v103
  s_waitcnt lgkmcnt(7)
  v_mfma_f32_32x32x16_bf16 v[64:79], v[132:135], a[4:7], v[64:79]
  v_exp_f32 v104, v104
  v_exp_f32 v105, v105
  v_exp_f32 v106, v106
  s_waitcnt lgkmcnt(6)
  v_mfma_f32_32x32x16_bf16 v[64:79], v[136:139], a[8:11], v[64:79]
  v_exp_f32 v107, v107
  v_exp_f32 v108, v108
  v_exp_f32 v109, v109
  s_waitcnt lgkmcnt(5)
  v_mfma_f32_32x32x16_bf16 v[64:79], v[140:143], a[12:15], v[64:79]
  v_exp_f32 v110, v110
  v_exp_f32 v111, v111
  ds_read_b64_tr_b16 a[64:65], v16 offset:16384
  ds_read_b64_tr_b16 a[66:67], v16 offset:16896
  s_waitcnt lgkmcnt(6)
  v_mfma_f32_32x32x16_bf16 v[64:79], v[144:147], a[16:19], v[64:79]
  ds_read_b64_tr_b16 a[68:69], v17 offset:16384
  ds_read_b64_tr_b16 a[70:71], v17 offset:16896
  ds_read_b64_tr_b16 a[72:73], v18 offset:16384
  ds_read_b64_tr_b16 a[74:75], v18 offset:16896
  v_mfma_f32_32x32x16_bf16 v[96:111], a[192:195], a[196:199], v[96:111]
  v_exp_f32 v112, v112
  v_exp_f32 v113, v113
  v_exp_f32 v114, v114
  s_waitcnt lgkmcnt(9)
  v_mfma_f32_32x32x16_bf16 v[64:79], v[148:151], a[20:23], v[64:79]
  v_exp_f32 v115, v115
  v_exp_f32 v116, v116
  v_exp_f32 v117, v117
  s_waitcnt lgkmcnt(8)
  v_mfma_f32_32x32x16_bf16 v[64:79], v[152:155], a[24:27], v[64:79]
  v_exp_f32 v118, v118
  v_exp_f32 v119, v119
  v_exp_f32 v120, v120
  s_waitcnt lgkmcnt(7)
  v_mfma_f32_32x32x16_bf16 v[64:79], v[156:159], a[28:31], v[64:79]
  v_rcp_f32 v96, v96
  v_rcp_f32 v97, v97
  v_rcp_f32 v98, v98
  v_mfma_f32_32x32x16_bf16 v[64:79], v[60:63], a[196:199], v[64:79]
  v_cvt_pk_bf16_f32 v44, v96, v97
  v_rcp_f32 v99, v99
  v_rcp_f32 v100, v100
  v_rcp_f32 v101, v101
  v_mfma_f32_32x32x16_bf16 v[80:95], v[160:163], a[0:3], 0
  v_cvt_pk_bf16_f32 v45, v98, v99
  v_rcp_f32 v102, v102
  v_cvt_pk_bf16_f32 v46, v100, v101
  v_rcp_f32 v103, v103
  v_mfma_f32_32x32x16_bf16 v[80:95], v[164:167], a[4:7], v[80:95]
  v_rcp_f32 v104, v104
  v_cvt_pk_bf16_f32 v47, v102, v103
  v_rcp_f32 v105, v105
  v_rcp_f32 v106, v106
  v_mfma_f32_16x16x32_bf16 v[32:35], v[44:47], a[144:147], v[32:35]
  v_cvt_pk_bf16_f32 v48, v104, v105
  v_rcp_f32 v107, v107
  v_mfma_f32_32x32x16_bf16 v[80:95], v[168:171], a[8:11], v[80:95]
  v_rcp_f32 v108, v108
  v_cvt_pk_bf16_f32 v49, v106, v107
  v_rcp_f32 v109, v109
  v_rcp_f32 v110, v110
  v_mfma_f32_32x32x16_bf16 v[80:95], v[172:175], a[12:15], v[80:95]
  v_cvt_pk_bf16_f32 v50, v108, v109
  v_rcp_f32 v111, v111
  v_exp_f32 v121, v121
  v_exp_f32 v122, v122
  v_mfma_f32_32x32x16_bf16 v[80:95], v[176:179], a[16:19], v[80:95]
  v_cvt_pk_bf16_f32 v51, v110, v111
  v_exp_f32 v123, v123
  v_exp_f32 v124, v124
  v_exp_f32 v125, v125
  v_mfma_f32_16x16x32_bf16 v[32:35], v[48:51], a[148:151], v[32:35]
  v_exp_f32 v126, v126
  v_mfma_f32_32x32x16_bf16 v[80:95], v[180:183], a[20:23], v[80:95]
  v_exp_f32 v127, v127
  ds_read_b64_tr_b16 a[76:77], v19 offset:16384
  ds_read_b64_tr_b16 a[78:79], v19 offset:16896
  ds_read_b64_tr_b16 a[80:81], v20 offset:16384
  v_mfma_f32_32x32x16_bf16 v[112:127], a[192:195], a[196:199], v[112:127]
  ds_read_b64_tr_b16 a[82:83], v20 offset:16896
  ds_read_b64_tr_b16 a[84:85], v21 offset:16384
  v_exp_f32 v64, v64
  v_exp_f32 v65, v65
  v_mfma_f32_32x32x16_bf16 v[80:95], v[184:187], a[24:27], v[80:95]
  v_exp_f32 v66, v66
  v_exp_f32 v67, v67
  v_exp_f32 v68, v68
  v_mfma_f32_32x32x16_bf16 v[80:95], v[188:191], a[28:31], v[80:95]
  v_exp_f32 v69, v69
  v_exp_f32 v70, v70
  v_exp_f32 v71, v71
  v_mfma_f32_32x32x16_bf16 v[80:95], v[60:63], a[200:203], v[80:95]
  v_rcp_f32 v112, v112
  v_rcp_f32 v113, v113
  v_rcp_f32 v114, v114
  v_mfma_f32_32x32x16_bf16 v[96:111], v[192:195], a[0:3], 0
  v_cvt_pk_bf16_f32 v44, v112, v113
  v_rcp_f32 v115, v115
  v_rcp_f32 v116, v116
  v_rcp_f32 v117, v117
  v_mfma_f32_32x32x16_bf16 v[96:111], v[196:199], a[4:7], v[96:111]
  v_cvt_pk_bf16_f32 v45, v114, v115
  v_rcp_f32 v118, v118
  v_cvt_pk_bf16_f32 v46, v116, v117
  v_rcp_f32 v119, v119
  v_mfma_f32_32x32x16_bf16 v[96:111], v[200:203], a[8:11], v[96:111]
  v_rcp_f32 v120, v120
  v_cvt_pk_bf16_f32 v47, v118, v119
  v_rcp_f32 v121, v121
  v_rcp_f32 v122, v122
  v_mfma_f32_16x16x32_bf16 v[32:35], v[44:47], a[152:155], v[32:35]
  v_cvt_pk_bf16_f32 v48, v120, v121
  v_rcp_f32 v123, v123
  v_mfma_f32_32x32x16_bf16 v[96:111], v[204:207], a[12:15], v[96:111]
  v_rcp_f32 v124, v124
  v_cvt_pk_bf16_f32 v49, v122, v123
  v_rcp_f32 v125, v125
  v_rcp_f32 v126, v126
  v_mfma_f32_32x32x16_bf16 v[96:111], v[208:211], a[16:19], v[96:111]
  v_cvt_pk_bf16_f32 v50, v124, v125
  v_rcp_f32 v127, v127
  v_exp_f32 v72, v72
  v_exp_f32 v73, v73
  v_mfma_f32_32x32x16_bf16 v[96:111], v[212:215], a[20:23], v[96:111]
  v_cvt_pk_bf16_f32 v51, v126, v127
  v_exp_f32 v74, v74
  v_exp_f32 v75, v75
  v_exp_f32 v76, v76
  v_mfma_f32_16x16x32_bf16 v[32:35], v[48:51], a[156:159], v[32:35]
  v_exp_f32 v77, v77
  v_mfma_f32_32x32x16_bf16 v[96:111], v[216:219], a[24:27], v[96:111]
  v_exp_f32 v78, v78
  v_exp_f32 v79, v79
  ds_read_b64_tr_b16 a[86:87], v21 offset:16896
  ds_read_b64_tr_b16 a[88:89], v22 offset:16384
  v_mfma_f32_32x32x16_bf16 v[96:111], v[220:223], a[28:31], v[96:111]
  ds_read_b64_tr_b16 a[90:91], v22 offset:16896
  s_waitcnt lgkmcnt(14)
  v_mul_legacy_f32 v32, v32, v36
  v_mul_legacy_f32 v33, v33, v37
  v_mul_legacy_f32 v34, v34, v38
  v_mul_legacy_f32 v35, v35, v39
  v_cvt_pk_bf16_f32 v40, v32, v33
  v_mfma_f32_32x32x16_bf16 v[64:79], a[192:195], a[196:199], v[64:79]
  v_cvt_pk_bf16_f32 v41, v34, v35
  v_mov_b32_dpp v42, v40 quad_perm:[1,0,3,2] row_mask:0xf bank_mask:0xf
  ds_read_b64_tr_b16 a[92:93], v23 offset:16384
  v_mov_b32_dpp v43, v41 quad_perm:[1,0,3,2] row_mask:0xf bank_mask:0xf
  ds_read_b64_tr_b16 a[94:95], v23 offset:16896
  v_mfma_f32_32x32x16_bf16 v[96:111], v[60:63], a[194:197], v[96:111]
  v_exp_f32 v80, v80
  v_exp_f32 v81, v81
  v_exp_f32 v82, v82
  v_mfma_f32_16x16x32_bf16 a[160:163], v[40:43], a[96:99], a[160:163]
  v_exp_f32 v83, v83
  v_mfma_f32_16x16x32_bf16 a[176:179], v[40:43], a[112:115], a[176:179]
  v_rcp_f32 v64, v64
  v_mfma_f32_16x16x32_bf16 a[164:167], v[40:43], a[100:103], a[164:167]
  v_rcp_f32 v65, v65
  v_mfma_f32_16x16x32_bf16 a[180:183], v[40:43], a[116:119], a[180:183]
  v_rcp_f32 v66, v66
  v_mfma_f32_16x16x32_bf16 a[168:171], v[40:43], a[104:107], a[168:171]
  v_cvt_pk_bf16_f32 v44, v64, v65
  v_rcp_f32 v67, v67
  v_mfma_f32_16x16x32_bf16 a[184:187], v[40:43], a[120:123], a[184:187]
  v_rcp_f32 v68, v68
  v_mfma_f32_16x16x32_bf16 a[172:175], v[40:43], a[108:111], a[172:175]
  v_cvt_pk_bf16_f32 v45, v66, v67
  v_rcp_f32 v69, v69
  v_mfma_f32_16x16x32_bf16 a[188:191], v[40:43], a[124:127], a[188:191]
  v_rcp_f32 v70, v70
  v_mfma_f32_32x32x16_bf16 v[112:127], v[224:227], a[0:3], 0
  v_cvt_pk_bf16_f32 v46, v68, v69
  v_rcp_f32 v71, v71
  v_rcp_f32 v72, v72
  v_rcp_f32 v73, v73
  v_mfma_f32_32x32x16_bf16 v[112:127], v[228:231], a[4:7], v[112:127]
  v_cvt_pk_bf16_f32 v47, v70, v71
  v_rcp_f32 v74, v74
  v_cvt_pk_bf16_f32 v48, v72, v73
  v_rcp_f32 v75, v75
  v_mfma_f32_16x16x32_bf16 v[32:35], v[44:47], a[128:131], v[28:31]
  v_rcp_f32 v76, v76
  v_mfma_f32_32x32x16_bf16 v[112:127], v[232:235], a[8:11], v[112:127]
  v_cvt_pk_bf16_f32 v49, v74, v75
  v_rcp_f32 v77, v77
  v_rcp_f32 v78, v78
  v_rcp_f32 v79, v79
  v_mfma_f32_32x32x16_bf16 v[112:127], v[236:239], a[12:15], v[112:127]
  v_cvt_pk_bf16_f32 v50, v76, v77
  v_exp_f32 v84, v84
  v_cvt_pk_bf16_f32 v51, v78, v79
  v_exp_f32 v85, v85
  v_mfma_f32_32x32x16_bf16 v[112:127], v[240:243], a[16:19], v[112:127]
  v_exp_f32 v86, v86
  v_exp_f32 v87, v87
  v_exp_f32 v88, v88
  v_mfma_f32_16x16x32_bf16 v[32:35], v[48:51], a[132:135], v[32:35]
  v_exp_f32 v89, v89
  v_mfma_f32_32x32x16_bf16 v[112:127], v[244:247], a[20:23], v[112:127]
  v_exp_f32 v90, v90
  v_exp_f32 v91, v91
  v_exp_f32 v92, v92
  v_mfma_f32_32x32x16_bf16 v[112:127], v[248:251], a[24:27], v[112:127]
  v_exp_f32 v93, v93
  v_exp_f32 v94, v94
  v_exp_f32 v95, v95
  v_mfma_f32_32x32x16_bf16 v[112:127], v[252:255], a[28:31], v[112:127]
  s_waitcnt vmcnt(0)
  ds_read_b128 a[32:35], v8 offset:24576
  v_exp_f32 v96, v96
  ds_read_b128 a[36:39], v9 offset:24576
  v_mfma_f32_32x32x16_bf16 v[80:95], a[192:195], a[196:199], v[80:95]
  ds_read_b128 a[40:43], v10 offset:24576
  v_exp_f32 v97, v97
  ds_read_b128 a[44:47], v11 offset:24576
  v_exp_f32 v98, v98
  v_mfma_f32_32x32x16_bf16 v[112:127], v[60:63], a[198:201], v[112:127]
  ds_read_b128 a[48:51], v12 offset:24576
  v_exp_f32 v99, v99
  ds_read_b128 a[52:55], v13 offset:24576
  v_exp_f32 v100, v100
  ds_read_b128 a[56:59], v14 offset:24576
  v_exp_f32 v101, v101
  ds_read_b128 a[60:63], v15 offset:24576
  v_rcp_f32 v80, v80
  v_rcp_f32 v81, v81
  v_rcp_f32 v82, v82
  v_rcp_f32 v83, v83
  v_cvt_pk_bf16_f32 v44, v80, v81
  v_rcp_f32 v84, v84
  s_waitcnt lgkmcnt(7)
  v_mfma_f32_32x32x16_bf16 v[64:79], v[128:131], a[32:35], 0
  v_cvt_pk_bf16_f32 v45, v82, v83
  v_rcp_f32 v85, v85
  v_rcp_f32 v86, v86
  v_rcp_f32 v87, v87
  s_waitcnt lgkmcnt(6)
  v_mfma_f32_32x32x16_bf16 v[64:79], v[132:135], a[36:39], v[64:79]
  v_cvt_pk_bf16_f32 v46, v84, v85
  v_rcp_f32 v88, v88
  v_cvt_pk_bf16_f32 v47, v86, v87
  v_rcp_f32 v89, v89
  s_waitcnt lgkmcnt(5)
  v_mfma_f32_32x32x16_bf16 v[64:79], v[136:139], a[40:43], v[64:79]
  v_rcp_f32 v90, v90
  v_cvt_pk_bf16_f32 v48, v88, v89
  v_rcp_f32 v91, v91
  v_rcp_f32 v92, v92
  v_mfma_f32_16x16x32_bf16 v[32:35], v[44:47], a[136:139], v[32:35]
  v_cvt_pk_bf16_f32 v49, v90, v91
  v_rcp_f32 v93, v93
  s_waitcnt lgkmcnt(4)
  v_mfma_f32_32x32x16_bf16 v[64:79], v[140:143], a[44:47], v[64:79]
  v_rcp_f32 v94, v94
  v_cvt_pk_bf16_f32 v50, v92, v93
  v_rcp_f32 v95, v95
  ds_read_b128 v[36:39], v52 offset:4352
  s_waitcnt lgkmcnt(4)
  v_mfma_f32_32x32x16_bf16 v[64:79], v[144:147], a[48:51], v[64:79]
  v_cvt_pk_bf16_f32 v51, v94, v95
  v_exp_f32 v102, v102
  v_exp_f32 v103, v103
  v_exp_f32 v104, v104
  v_mfma_f32_16x16x32_bf16 v[32:35], v[48:51], a[140:143], v[32:35]
  v_exp_f32 v105, v105
  s_waitcnt lgkmcnt(3)
  v_mfma_f32_32x32x16_bf16 v[64:79], v[148:151], a[52:55], v[64:79]
  v_exp_f32 v106, v106
  v_exp_f32 v107, v107
  v_exp_f32 v108, v108
  s_waitcnt lgkmcnt(2)
  v_mfma_f32_32x32x16_bf16 v[64:79], v[152:155], a[56:59], v[64:79]
  v_exp_f32 v109, v109
  v_exp_f32 v110, v110
  v_exp_f32 v111, v111
  s_waitcnt lgkmcnt(1)
  v_mfma_f32_32x32x16_bf16 v[64:79], v[156:159], a[60:63], v[64:79]
  ds_read_b64_tr_b16 a[96:97], v16 offset:24576
  ds_read_b64_tr_b16 a[98:99], v16 offset:25088
  ds_read_b64_tr_b16 a[100:101], v17 offset:24576
  ds_read_b64_tr_b16 a[102:103], v17 offset:25088
  v_mfma_f32_32x32x16_bf16 v[96:111], a[192:195], a[196:199], v[96:111]
  ds_read_b64_tr_b16 a[104:105], v18 offset:24576
  ds_read_b64_tr_b16 a[106:107], v18 offset:25088
  v_exp_f32 v112, v112
  v_exp_f32 v113, v113
  v_mfma_f32_32x32x16_bf16 v[64:79], v[60:63], a[196:199], v[64:79]
  v_exp_f32 v114, v114
  v_exp_f32 v115, v115
  v_exp_f32 v116, v116
  v_mfma_f32_32x32x16_bf16 v[80:95], v[160:163], a[32:35], 0
  v_exp_f32 v117, v117
  v_exp_f32 v118, v118
  v_exp_f32 v119, v119
  v_mfma_f32_32x32x16_bf16 v[80:95], v[164:167], a[36:39], v[80:95]
  v_rcp_f32 v96, v96
  v_rcp_f32 v97, v97
  v_rcp_f32 v98, v98
  v_mfma_f32_32x32x16_bf16 v[80:95], v[168:171], a[40:43], v[80:95]
  v_cvt_pk_bf16_f32 v44, v96, v97
  v_rcp_f32 v99, v99
  v_rcp_f32 v100, v100
  v_rcp_f32 v101, v101
  v_mfma_f32_32x32x16_bf16 v[80:95], v[172:175], a[44:47], v[80:95]
  v_cvt_pk_bf16_f32 v45, v98, v99
  v_rcp_f32 v102, v102
  v_cvt_pk_bf16_f32 v46, v100, v101
  v_rcp_f32 v103, v103
  v_mfma_f32_32x32x16_bf16 v[80:95], v[176:179], a[48:51], v[80:95]
  v_rcp_f32 v104, v104
  v_cvt_pk_bf16_f32 v47, v102, v103
  v_rcp_f32 v105, v105
  v_rcp_f32 v106, v106
  v_mfma_f32_16x16x32_bf16 v[32:35], v[44:47], a[144:147], v[32:35]
  v_cvt_pk_bf16_f32 v48, v104, v105
  v_rcp_f32 v107, v107
  v_mfma_f32_32x32x16_bf16 v[80:95], v[180:183], a[52:55], v[80:95]
  v_rcp_f32 v108, v108
  v_cvt_pk_bf16_f32 v49, v106, v107
  v_rcp_f32 v109, v109
  v_rcp_f32 v110, v110
  v_mfma_f32_32x32x16_bf16 v[80:95], v[184:187], a[56:59], v[80:95]
  v_cvt_pk_bf16_f32 v50, v108, v109
  v_rcp_f32 v111, v111
  v_exp_f32 v120, v120
  v_exp_f32 v121, v121
  v_mfma_f32_32x32x16_bf16 v[80:95], v[188:191], a[60:63], v[80:95]
  v_cvt_pk_bf16_f32 v51, v110, v111
  v_exp_f32 v122, v122
  v_exp_f32 v123, v123
  v_exp_f32 v124, v124
  v_mfma_f32_16x16x32_bf16 v[32:35], v[48:51], a[148:151], v[32:35]
  v_exp_f32 v125, v125
  v_mfma_f32_32x32x16_bf16 v[80:95], v[60:63], a[200:203], v[80:95]
  v_exp_f32 v126, v126
  v_exp_f32 v127, v127
  ds_read_b64_tr_b16 a[108:109], v19 offset:24576
  ds_read_b64_tr_b16 a[110:111], v19 offset:25088
  v_mfma_f32_32x32x16_bf16 v[96:111], v[192:195], a[32:35], 0
  ds_read_b64_tr_b16 a[112:113], v20 offset:24576
  ds_read_b64_tr_b16 a[114:115], v20 offset:25088
  ds_read_b64_tr_b16 a[116:117], v21 offset:24576
  v_exp_f32 v64, v64
  v_mfma_f32_32x32x16_bf16 v[112:127], a[192:195], a[196:199], v[112:127]
  v_exp_f32 v65, v65
  v_exp_f32 v66, v66
  v_exp_f32 v67, v67
  v_mfma_f32_32x32x16_bf16 v[96:111], v[196:199], a[36:39], v[96:111]
  v_exp_f32 v68, v68
  v_exp_f32 v69, v69
  v_exp_f32 v70, v70
  v_mfma_f32_32x32x16_bf16 v[96:111], v[200:203], a[40:43], v[96:111]
  v_exp_f32 v71, v71
  v_exp_f32 v72, v72
  v_exp_f32 v73, v73
  v_mfma_f32_32x32x16_bf16 v[96:111], v[204:207], a[44:47], v[96:111]
  v_rcp_f32 v112, v112
  v_rcp_f32 v113, v113
  v_rcp_f32 v114, v114
  v_mfma_f32_32x32x16_bf16 v[96:111], v[208:211], a[48:51], v[96:111]
  v_cvt_pk_bf16_f32 v44, v112, v113
  v_rcp_f32 v115, v115
  v_rcp_f32 v116, v116
  v_rcp_f32 v117, v117
  v_mfma_f32_32x32x16_bf16 v[96:111], v[212:215], a[52:55], v[96:111]
  v_cvt_pk_bf16_f32 v45, v114, v115
  v_rcp_f32 v118, v118
  v_cvt_pk_bf16_f32 v46, v116, v117
  v_rcp_f32 v119, v119
  v_mfma_f32_32x32x16_bf16 v[96:111], v[216:219], a[56:59], v[96:111]
  v_rcp_f32 v120, v120
  v_cvt_pk_bf16_f32 v47, v118, v119
  v_rcp_f32 v121, v121
  v_rcp_f32 v122, v122
  v_mfma_f32_16x16x32_bf16 v[32:35], v[44:47], a[152:155], v[32:35]
  v_cvt_pk_bf16_f32 v48, v120, v121
  v_rcp_f32 v123, v123
  v_mfma_f32_32x32x16_bf16 v[96:111], v[220:223], a[60:63], v[96:111]
  v_rcp_f32 v124, v124
  v_cvt_pk_bf16_f32 v49, v122, v123
  v_rcp_f32 v125, v125
  v_rcp_f32 v126, v126
  v_mfma_f32_32x32x16_bf16 v[96:111], v[60:63], a[194:197], v[96:111]
  v_cvt_pk_bf16_f32 v50, v124, v125
  v_rcp_f32 v127, v127
  v_exp_f32 v74, v74
  v_exp_f32 v75, v75
  v_cvt_pk_bf16_f32 v51, v126, v127
  v_mfma_f32_32x32x16_bf16 v[112:127], v[224:227], a[32:35], 0
  v_exp_f32 v76, v76
  v_exp_f32 v77, v77
  v_exp_f32 v78, v78
  v_mfma_f32_16x16x32_bf16 v[32:35], v[48:51], a[156:159], v[32:35]
  v_exp_f32 v79, v79
  v_mfma_f32_32x32x16_bf16 v[112:127], v[228:231], a[36:39], v[112:127]
  ds_read_b64_tr_b16 a[118:119], v21 offset:25088
  ds_read_b64_tr_b16 a[120:121], v22 offset:24576
  ds_read_b64_tr_b16 a[122:123], v22 offset:25088
  ds_read_b64_tr_b16 a[124:125], v23 offset:24576
  v_mfma_f32_32x32x16_bf16 v[64:79], a[192:195], a[196:199], v[64:79]
  ds_read_b64_tr_b16 a[126:127], v23 offset:25088
  s_waitcnt lgkmcnt(15)
  v_mul_legacy_f32 v32, v32, v36
  v_mul_legacy_f32 v33, v33, v37
  v_mul_legacy_f32 v34, v34, v38
  v_mul_legacy_f32 v35, v35, v39
  v_cvt_pk_bf16_f32 v40, v32, v33
  v_mfma_f32_32x32x16_bf16 v[112:127], v[232:235], a[40:43], v[112:127]
  v_cvt_pk_bf16_f32 v41, v34, v35
  v_mov_b32_dpp v42, v40 quad_perm:[1,0,3,2] row_mask:0xf bank_mask:0xf
  v_exp_f32 v80, v80
  v_mov_b32_dpp v43, v41 quad_perm:[1,0,3,2] row_mask:0xf bank_mask:0xf
  v_exp_f32 v81, v81
  v_mfma_f32_32x32x16_bf16 v[112:127], v[236:239], a[44:47], v[112:127]
  v_rcp_f32 v64, v64
  v_rcp_f32 v65, v65
  v_rcp_f32 v66, v66
  v_mfma_f32_16x16x32_bf16 a[160:163], v[40:43], a[64:67], a[160:163]
  v_cvt_pk_bf16_f32 v44, v64, v65
  v_rcp_f32 v67, v67
  v_mfma_f32_16x16x32_bf16 a[176:179], v[40:43], a[80:83], a[176:179]
  v_rcp_f32 v68, v68
  v_mfma_f32_16x16x32_bf16 a[164:167], v[40:43], a[68:71], a[164:167]
  v_cvt_pk_bf16_f32 v45, v66, v67
  v_rcp_f32 v69, v69
  v_mfma_f32_16x16x32_bf16 a[180:183], v[40:43], a[84:87], a[180:183]
  v_rcp_f32 v70, v70
  v_mfma_f32_16x16x32_bf16 a[168:171], v[40:43], a[72:75], a[168:171]
  v_cvt_pk_bf16_f32 v46, v68, v69
  v_rcp_f32 v71, v71
  v_mfma_f32_16x16x32_bf16 a[184:187], v[40:43], a[88:91], a[184:187]
  v_rcp_f32 v72, v72
  v_mfma_f32_16x16x32_bf16 a[172:175], v[40:43], a[76:79], a[172:175]
  v_cvt_pk_bf16_f32 v47, v70, v71
  v_rcp_f32 v73, v73
  v_mfma_f32_16x16x32_bf16 a[188:191], v[40:43], a[92:95], a[188:191]
  v_rcp_f32 v74, v74
  v_mfma_f32_16x16x32_bf16 v[32:35], v[44:47], a[128:131], v[28:31]
  v_cvt_pk_bf16_f32 v48, v72, v73
  v_rcp_f32 v75, v75
  v_mfma_f32_32x32x16_bf16 v[112:127], v[240:243], a[48:51], v[112:127]
  v_rcp_f32 v76, v76
  v_cvt_pk_bf16_f32 v49, v74, v75
  v_rcp_f32 v77, v77
  v_rcp_f32 v78, v78
  v_mfma_f32_32x32x16_bf16 v[112:127], v[244:247], a[52:55], v[112:127]
  v_cvt_pk_bf16_f32 v50, v76, v77
  v_rcp_f32 v79, v79
  v_exp_f32 v82, v82
  v_exp_f32 v83, v83
  v_mfma_f32_32x32x16_bf16 v[112:127], v[248:251], a[56:59], v[112:127]
  v_cvt_pk_bf16_f32 v51, v78, v79
  v_exp_f32 v84, v84
  v_exp_f32 v85, v85
  v_exp_f32 v86, v86
  v_mfma_f32_16x16x32_bf16 v[32:35], v[48:51], a[132:135], v[32:35]
  v_exp_f32 v87, v87
  v_mfma_f32_32x32x16_bf16 v[112:127], v[252:255], a[60:63], v[112:127]
  v_exp_f32 v88, v88
  v_exp_f32 v89, v89
  v_exp_f32 v90, v90
  v_mfma_f32_32x32x16_bf16 v[112:127], v[60:63], a[198:201], v[112:127]
  v_exp_f32 v91, v91
  v_exp_f32 v92, v92
  v_exp_f32 v93, v93
  v_exp_f32 v94, v94
  v_exp_f32 v95, v95
  ds_read_b128 v[36:39], v52 offset:4480
  v_exp_f32 v96, v96
  v_exp_f32 v97, v97
  v_mfma_f32_32x32x16_bf16 v[80:95], a[192:195], a[196:199], v[80:95]
  v_exp_f32 v98, v98
  v_exp_f32 v99, v99
  v_exp_f32 v100, v100
  v_exp_f32 v101, v101
  v_exp_f32 v102, v102
  v_exp_f32 v103, v103
  v_exp_f32 v104, v104
  v_exp_f32 v105, v105
  v_exp_f32 v106, v106
  v_exp_f32 v107, v107
  v_exp_f32 v108, v108
  v_exp_f32 v109, v109
  v_exp_f32 v110, v110
  v_exp_f32 v111, v111
  v_rcp_f32 v80, v80
  v_rcp_f32 v81, v81
  v_rcp_f32 v82, v82
  v_mfma_f32_32x32x16_bf16 v[96:111], a[192:195], a[196:199], v[96:111]
  v_cvt_pk_bf16_f32 v44, v80, v81
  v_rcp_f32 v83, v83
  v_rcp_f32 v84, v84
  v_rcp_f32 v85, v85
  v_cvt_pk_bf16_f32 v45, v82, v83
  v_rcp_f32 v86, v86
  v_rcp_f32 v87, v87
  v_cvt_pk_bf16_f32 v46, v84, v85
  v_rcp_f32 v88, v88
  v_rcp_f32 v89, v89
  v_cvt_pk_bf16_f32 v47, v86, v87
  v_rcp_f32 v90, v90
  v_rcp_f32 v91, v91
  v_mfma_f32_16x16x32_bf16 v[32:35], v[44:47], a[136:139], v[32:35]
  v_cvt_pk_bf16_f32 v48, v88, v89
  v_rcp_f32 v92, v92
  v_cvt_pk_bf16_f32 v49, v90, v91
  v_rcp_f32 v93, v93
  v_rcp_f32 v94, v94
  v_rcp_f32 v95, v95
  v_cvt_pk_bf16_f32 v50, v92, v93
  v_exp_f32 v112, v112
  v_exp_f32 v113, v113
  v_cvt_pk_bf16_f32 v51, v94, v95
  v_exp_f32 v114, v114
  v_exp_f32 v115, v115
  v_mfma_f32_16x16x32_bf16 v[32:35], v[48:51], a[140:143], v[32:35]
  v_exp_f32 v116, v116
  v_exp_f32 v117, v117
  v_exp_f32 v118, v118
  v_exp_f32 v119, v119
  v_exp_f32 v120, v120
  v_exp_f32 v121, v121
  v_exp_f32 v122, v122
  v_exp_f32 v123, v123
  v_exp_f32 v124, v124
  v_exp_f32 v125, v125
  v_exp_f32 v126, v126
  v_exp_f32 v127, v127
  v_rcp_f32 v96, v96
  v_rcp_f32 v97, v97
  v_rcp_f32 v98, v98
  v_mfma_f32_32x32x16_bf16 v[112:127], a[192:195], a[196:199], v[112:127]
  v_cvt_pk_bf16_f32 v44, v96, v97
  v_rcp_f32 v99, v99
  v_rcp_f32 v100, v100
  v_rcp_f32 v101, v101
  v_cvt_pk_bf16_f32 v45, v98, v99
  v_rcp_f32 v102, v102
  v_rcp_f32 v103, v103
  v_cvt_pk_bf16_f32 v46, v100, v101
  v_rcp_f32 v104, v104
  v_rcp_f32 v105, v105
  v_cvt_pk_bf16_f32 v47, v102, v103
  v_rcp_f32 v106, v106
  v_rcp_f32 v107, v107
  v_mfma_f32_16x16x32_bf16 v[32:35], v[44:47], a[144:147], v[32:35]
  v_cvt_pk_bf16_f32 v48, v104, v105
  v_rcp_f32 v108, v108
  v_cvt_pk_bf16_f32 v49, v106, v107
  v_rcp_f32 v109, v109
  v_rcp_f32 v110, v110
  v_rcp_f32 v111, v111
  v_cvt_pk_bf16_f32 v50, v108, v109
  v_rcp_f32 v112, v112
  v_rcp_f32 v113, v113
  v_cvt_pk_bf16_f32 v51, v110, v111
  v_rcp_f32 v114, v114
  v_rcp_f32 v115, v115
  v_mfma_f32_16x16x32_bf16 v[32:35], v[48:51], a[148:151], v[32:35]
  v_cvt_pk_bf16_f32 v44, v112, v113
  v_rcp_f32 v116, v116
  v_cvt_pk_bf16_f32 v45, v114, v115
  v_rcp_f32 v117, v117
  v_rcp_f32 v118, v118
  v_rcp_f32 v119, v119
  v_cvt_pk_bf16_f32 v46, v116, v117
  v_rcp_f32 v120, v120
  v_rcp_f32 v121, v121
  v_cvt_pk_bf16_f32 v47, v118, v119
  v_rcp_f32 v122, v122
  v_rcp_f32 v123, v123
  v_mfma_f32_16x16x32_bf16 v[32:35], v[44:47], a[152:155], v[32:35]
  v_cvt_pk_bf16_f32 v48, v120, v121
  v_rcp_f32 v124, v124
  v_cvt_pk_bf16_f32 v49, v122, v123
  v_rcp_f32 v125, v125
  v_rcp_f32 v126, v126
  v_rcp_f32 v127, v127
  v_cvt_pk_bf16_f32 v50, v124, v125
  v_mbcnt_lo_u32_b32 v66, -1, 0
  v_mbcnt_hi_u32_b32 v66, -1, v66
  v_cvt_pk_bf16_f32 v51, v126, v127
  v_lshlrev_b32 v66, 1, v66
  s_nop 0
  v_mfma_f32_16x16x32_bf16 v[32:35], v[48:51], a[156:159], v[32:35]
  s_waitcnt lgkmcnt(0)
  s_nop 6
  v_mul_legacy_f32 v32, v32, v36
  v_mul_legacy_f32 v33, v33, v37
  v_mul_legacy_f32 v34, v34, v38
  v_mul_legacy_f32 v35, v35, v39
  v_cvt_pk_bf16_f32 v40, v32, v33
  v_cvt_pk_bf16_f32 v41, v34, v35
  s_nop 0
  v_mov_b32_dpp v42, v40 quad_perm:[1,0,3,2] row_mask:0xf bank_mask:0xf
  v_mov_b32_dpp v43, v41 quad_perm:[1,0,3,2] row_mask:0xf bank_mask:0xf
  s_nop 1
  v_mfma_f32_16x16x32_bf16 a[160:163], v[40:43], a[96:99], a[160:163]
  v_mfma_f32_16x16x32_bf16 a[176:179], v[40:43], a[112:115], a[176:179]
  v_mfma_f32_16x16x32_bf16 a[164:167], v[40:43], a[100:103], a[164:167]
  v_mfma_f32_16x16x32_bf16 a[180:183], v[40:43], a[116:119], a[180:183]
  v_mfma_f32_16x16x32_bf16 a[168:171], v[40:43], a[104:107], a[168:171]
  v_mfma_f32_16x16x32_bf16 a[184:187], v[40:43], a[120:123], a[184:187]
  v_mfma_f32_16x16x32_bf16 a[172:175], v[40:43], a[108:111], a[172:175]
  v_mfma_f32_16x16x32_bf16 a[188:191], v[40:43], a[124:127], a[188:191]
  s_nop 0
  v_accvgpr_read_b32 v68, a160
  v_accvgpr_read_b32 v69, a176
  v_cvt_pk_bf16_f32 v64, v68, v69
  v_accvgpr_read_b32 v70, a164
  v_accvgpr_read_b32 v71, a180
  v_cvt_pk_bf16_f32 v70, v70, v71
  v_accvgpr_read_b32 v72, a168
  v_accvgpr_read_b32 v73, a184
  v_mov_b32_dpp v64, v70 quad_perm:[0,1,2,3] row_mask:0x2 bank_mask:0xf
  v_cvt_pk_bf16_f32 v72, v72, v73
  v_accvgpr_read_b32 v74, a172
  v_accvgpr_read_b32 v75, a188
  v_mov_b32_dpp v64, v72 quad_perm:[0,1,2,3] row_mask:0x4 bank_mask:0xf
  v_cvt_pk_bf16_f32 v74, v74, v75
  s_nop 1
  v_mov_b32_dpp v64, v74 quad_perm:[0,1,2,3] row_mask:0x8 bank_mask:0xf
L_store:
  buffer_store_short v64, v66, s[60:63], 0 offen
  buffer_store_short_d16_hi v64, v66, s[60:63], 0 offen offset:128
L_end:
  s_endpgm
L_wrap:
  s_cmp_gt_u32 s13, 192
  s_cbranch_scc1 L_t7
  s_cmp_gt_u32 s13, 160
  s_cbranch_scc1 L_t6
L_t5:
  v_mfma_f32_32x32x16_bf16 v[112:127], v[224:227], a[32:35], 0
  s_waitcnt vmcnt(8)
  ds_read_b128 a[0:3], v8 offset:16384
  s_nop 1
  v_rcp_f32 v80, v80
  v_rcp_f32 v81, v81
  v_mfma_f32_32x32x16_bf16 v[112:127], v[228:231], a[36:39], v[112:127]
  ds_read_b128 v[0:3], v53 offset:512
  v_cvt_pk_bf16_f32 v44, v80, v81
  v_rcp_f32 v82, v82
  ds_read_b128 a[4:7], v9 offset:16384
  v_mfma_f32_32x32x16_bf16 v[112:127], v[232:235], a[40:43], v[112:127]
  v_rcp_f32 v83, v83
  v_rcp_f32 v84, v84
  v_rcp_f32 v85, v85
  v_mfma_f32_32x32x16_bf16 v[112:127], v[236:239], a[44:47], v[112:127]
  v_cvt_pk_bf16_f32 v45, v82, v83
  ds_read_b128 a[8:11], v10 offset:16384
  v_cvt_pk_bf16_f32 v46, v84, v85
  v_rcp_f32 v86, v86
  v_mfma_f32_32x32x16_bf16 v[112:127], v[240:243], a[48:51], v[112:127]
  v_rcp_f32 v87, v87
  v_rcp_f32 v88, v88
  ds_read_b128 a[12:15], v11 offset:16384
  v_cvt_pk_bf16_f32 v47, v86, v87
  v_mfma_f32_32x32x16_bf16 v[112:127], v[244:247], a[52:55], v[112:127]
  s_add_u32 m0, s14, 0
  v_rcp_f32 v89, v89
  ds_read_b128 a[16:19], v12 offset:16384
  v_rcp_f32 v90, v90
  v_mfma_f32_16x16x32_bf16 v[32:35], v[44:47], a[136:139], v[32:35]
  s_waitcnt lgkmcnt(4)
  v_xad_u32 v0, v54, 0, v0
  buffer_load_dwordx4 v0, s[36:39], s52 offen offset:0 nt lds
  v_mfma_f32_32x32x16_bf16 v[112:127], v[248:251], a[56:59], v[112:127]
  v_cvt_pk_bf16_f32 v48, v88, v89
  v_rcp_f32 v91, v91
  v_rcp_f32 v92, v92
  v_rcp_f32 v93, v93
  v_mfma_f32_32x32x16_bf16 v[112:127], v[252:255], a[60:63], v[112:127]
  v_cvt_pk_bf16_f32 v49, v90, v91
  ds_read_b128 a[20:23], v13 offset:16384
  v_cvt_pk_bf16_f32 v50, v92, v93
  v_rcp_f32 v94, v94
  v_mfma_f32_32x32x16_bf16 v[112:127], v[60:63], a[198:201], v[112:127]
  v_rcp_f32 v95, v95
  ds_read_b128 a[24:27], v14 offset:16384
  v_xad_u32 v1, v54, 32, v1
  buffer_load_dwordx4 v1, s[36:39], s53 offen offset:1024 nt lds
  v_mfma_f32_32x32x16_bf16 v[64:79], v[128:131], a[0:3], 0
  v_cvt_pk_bf16_f32 v51, v94, v95
  v_exp_f32 v96, v96
  v_exp_f32 v97, v97
  v_exp_f32 v98, v98
  v_mfma_f32_16x16x32_bf16 v[32:35], v[48:51], a[140:143], v[32:35]
  ds_read_b128 a[28:31], v15 offset:16384
  v_exp_f32 v99, v99
  s_waitcnt lgkmcnt(6)
  v_mfma_f32_32x32x16_bf16 v[64:79], v[132:135], a[4:7], v[64:79]
  v_exp_f32 v100, v100
  v_exp_f32 v101, v101
  v_exp_f32 v102, v102
  s_waitcnt lgkmcnt(5)
  v_mfma_f32_32x32x16_bf16 v[64:79], v[136:139], a[8:11], v[64:79]
  v_exp_f32 v103, v103
  ds_read_b128 v[36:39], v52 offset:4224
  v_exp_f32 v104, v104
  v_exp_f32 v105, v105
  s_waitcnt lgkmcnt(5)
  v_mfma_f32_32x32x16_bf16 v[64:79], v[140:143], a[12:15], v[64:79]
  v_exp_f32 v106, v106
  v_exp_f32 v107, v107
  v_exp_f32 v108, v108
  s_waitcnt lgkmcnt(4)
  v_mfma_f32_32x32x16_bf16 v[64:79], v[144:147], a[16:19], v[64:79]
  v_exp_f32 v109, v109
  v_exp_f32 v110, v110
  v_exp_f32 v111, v111
  s_waitcnt lgkmcnt(3)
  v_mfma_f32_32x32x16_bf16 v[64:79], v[148:151], a[20:23], v[64:79]
  ds_read_b64_tr_b16 a[64:65], v16 offset:16384
  v_xad_u32 v2, v54, 64, v2
  buffer_load_dwordx4 v2, s[36:39], s54 offen offset:2048 nt lds
  v_mfma_f32_32x32x16_bf16 v[96:111], a[192:195], a[196:199], v[96:111]
  ds_read_b64_tr_b16 a[66:67], v16 offset:16896
  ds_read_b64_tr_b16 a[68:69], v17 offset:16384
  ds_read_b64_tr_b16 a[70:71], v17 offset:16896
  v_xad_u32 v3, v54, s55, v3
  s_waitcnt lgkmcnt(6)
  v_mfma_f32_32x32x16_bf16 v[64:79], v[152:155], a[24:27], v[64:79]
  ds_read_b64_tr_b16 a[72:73], v18 offset:16384
  ds_read_b64_tr_b16 a[74:75], v18 offset:16896
  v_exp_f32 v112, v112
  v_exp_f32 v113, v113
  s_waitcnt lgkmcnt(7)
  v_mfma_f32_32x32x16_bf16 v[64:79], v[156:159], a[28:31], v[64:79]
  buffer_load_dwordx4 v3, s[36:39], 0 offen offset:3072 nt lds
  v_exp_f32 v114, v114
  v_rcp_f32 v96, v96
  v_mfma_f32_32x32x16_bf16 v[64:79], v[60:63], a[196:199], v[64:79]
  v_rcp_f32 v97, v97
  v_rcp_f32 v98, v98
  v_rcp_f32 v99, v99
  v_mfma_f32_32x32x16_bf16 v[80:95], v[160:163], a[0:3], 0
  v_cvt_pk_bf16_f32 v44, v96, v97
  v_rcp_f32 v100, v100
  v_cvt_pk_bf16_f32 v45, v98, v99
  v_rcp_f32 v101, v101
  v_mfma_f32_32x32x16_bf16 v[80:95], v[164:167], a[4:7], v[80:95]
  v_rcp_f32 v102, v102
  v_cvt_pk_bf16_f32 v46, v100, v101
  v_rcp_f32 v103, v103
  v_rcp_f32 v104, v104
  v_mfma_f32_32x32x16_bf16 v[80:95], v[168:171], a[8:11], v[80:95]
  v_cvt_pk_bf16_f32 v47, v102, v103
  v_rcp_f32 v105, v105
  v_rcp_f32 v106, v106
  v_rcp_f32 v107, v107
  v_mfma_f32_16x16x32_bf16 v[32:35], v[44:47], a[144:147], v[32:35]
  v_cvt_pk_bf16_f32 v48, v104, v105
  v_rcp_f32 v108, v108
  v_mfma_f32_32x32x16_bf16 v[80:95], v[172:175], a[12:15], v[80:95]
  v_cvt_pk_bf16_f32 v49, v106, v107
  v_rcp_f32 v109, v109
  v_rcp_f32 v110, v110
  v_rcp_f32 v111, v111
  v_mfma_f32_32x32x16_bf16 v[80:95], v[176:179], a[16:19], v[80:95]
  v_cvt_pk_bf16_f32 v50, v108, v109
  v_exp_f32 v115, v115
  v_cvt_pk_bf16_f32 v51, v110, v111
  v_exp_f32 v116, v116
  v_mfma_f32_32x32x16_bf16 v[80:95], v[180:183], a[20:23], v[80:95]
  v_exp_f32 v117, v117
  v_exp_f32 v118, v118
  v_exp_f32 v119, v119
  v_mfma_f32_16x16x32_bf16 v[32:35], v[48:51], a[148:151], v[32:35]
  v_exp_f32 v120, v120
  v_mfma_f32_32x32x16_bf16 v[80:95], v[184:187], a[24:27], v[80:95]
  v_exp_f32 v121, v121
  v_exp_f32 v122, v122
  v_exp_f32 v123, v123
  v_mfma_f32_32x32x16_bf16 v[80:95], v[188:191], a[28:31], v[80:95]
  v_exp_f32 v124, v124
  v_exp_f32 v125, v125
  v_exp_f32 v126, v126
  v_mfma_f32_32x32x16_bf16 v[80:95], v[60:63], a[200:203], v[80:95]
  v_exp_f32 v127, v127
  ds_read_b64_tr_b16 a[76:77], v19 offset:16384
  ds_read_b128 v[4:7], v53 offset:528
  s_add_u32 m0, s14, 4096
  v_mfma_f32_32x32x16_bf16 v[96:111], v[192:195], a[0:3], 0
  ds_read_b64_tr_b16 a[78:79], v19 offset:16896
  ds_read_b64_tr_b16 a[80:81], v20 offset:16384
  ds_read_b64_tr_b16 a[82:83], v20 offset:16896
  ds_read_b64_tr_b16 a[84:85], v21 offset:16384
  v_mfma_f32_32x32x16_bf16 v[112:127], a[192:195], a[196:199], v[112:127]
  v_exp_f32 v64, v64
  v_exp_f32 v65, v65
  v_exp_f32 v66, v66
  v_mfma_f32_32x32x16_bf16 v[96:111], v[196:199], a[4:7], v[96:111]
  v_exp_f32 v67, v67
  v_exp_f32 v68, v68
  v_exp_f32 v69, v69
  v_mfma_f32_32x32x16_bf16 v[96:111], v[200:203], a[8:11], v[96:111]
  v_exp_f32 v70, v70
  v_exp_f32 v71, v71
  v_exp_f32 v72, v72
  v_mfma_f32_32x32x16_bf16 v[96:111], v[204:207], a[12:15], v[96:111]
  v_rcp_f32 v112, v112
  v_rcp_f32 v113, v113
  v_rcp_f32 v114, v114
  v_mfma_f32_32x32x16_bf16 v[96:111], v[208:211], a[16:19], v[96:111]
  v_cvt_pk_bf16_f32 v44, v112, v113
  v_rcp_f32 v115, v115
  v_rcp_f32 v116, v116
  v_rcp_f32 v117, v117
  v_mfma_f32_32x32x16_bf16 v[96:111], v[212:215], a[20:23], v[96:111]
  v_cvt_pk_bf16_f32 v45, v114, v115
  v_rcp_f32 v118, v118
  v_cvt_pk_bf16_f32 v46, v116, v117
  v_rcp_f32 v119, v119
  v_mfma_f32_32x32x16_bf16 v[96:111], v[216:219], a[24:27], v[96:111]
  v_rcp_f32 v120, v120
  v_cvt_pk_bf16_f32 v47, v118, v119
  s_waitcnt lgkmcnt(4)
  v_xad_u32 v4, v54, s72, v4
  buffer_load_dwordx4 v4, s[36:39], s52 offen offset:0 nt lds
  v_mfma_f32_16x16x32_bf16 v[32:35], v[44:47], a[152:155], v[32:35]
  v_rcp_f32 v121, v121
  v_mfma_f32_32x32x16_bf16 v[96:111], v[220:223], a[28:31], v[96:111]
  v_rcp_f32 v122, v122
  v_cvt_pk_bf16_f32 v48, v120, v121
  v_rcp_f32 v123, v123
  v_rcp_f32 v124, v124
  v_mfma_f32_32x32x16_bf16 v[96:111], v[60:63], a[194:197], v[96:111]
  v_cvt_pk_bf16_f32 v49, v122, v123
  v_rcp_f32 v125, v125
  v_rcp_f32 v126, v126
  v_rcp_f32 v127, v127
  v_cvt_pk_bf16_f32 v50, v124, v125
  v_xad_u32 v5, v54, s73, v5
  buffer_load_dwordx4 v5, s[36:39], s53 offen offset:1024 nt lds
  v_cvt_pk_bf16_f32 v51, v126, v127
  v_mfma_f32_32x32x16_bf16 v[112:127], v[224:227], a[0:3], 0
  v_exp_f32 v73, v73
  v_exp_f32 v74, v74
  v_exp_f32 v75, v75
  v_mfma_f32_16x16x32_bf16 v[32:35], v[48:51], a[156:159], v[32:35]
  v_exp_f32 v76, v76
  v_mfma_f32_32x32x16_bf16 v[112:127], v[228:231], a[4:7], v[112:127]
  v_exp_f32 v77, v77
  v_exp_f32 v78, v78
  v_exp_f32 v79, v79
  v_mfma_f32_32x32x16_bf16 v[112:127], v[232:235], a[8:11], v[112:127]
  ds_read_b64_tr_b16 a[86:87], v21 offset:16896
  v_xad_u32 v6, v54, s74, v6
  v_mul_legacy_f32 v32, v32, v36
  v_mul_legacy_f32 v33, v33, v37
  v_mul_legacy_f32 v34, v34, v38
  v_mfma_f32_32x32x16_bf16 v[64:79], a[192:195], a[196:199], v[64:79]
  v_mul_legacy_f32 v35, v35, v39
  v_cvt_pk_bf16_f32 v40, v32, v33
  v_cvt_pk_bf16_f32 v41, v34, v35
  buffer_load_dwordx4 v6, s[36:39], s54 offen offset:2048 nt lds
  v_mfma_f32_32x32x16_bf16 v[112:127], v[236:239], a[12:15], v[112:127]
  v_mov_b32_dpp v42, v40 quad_perm:[1,0,3,2] row_mask:0xf bank_mask:0xf
  v_mov_b32_dpp v43, v41 quad_perm:[1,0,3,2] row_mask:0xf bank_mask:0xf
  ds_read_b64_tr_b16 a[88:89], v22 offset:16384
  ds_read_b64_tr_b16 a[90:91], v22 offset:16896
  v_mfma_f32_16x16x32_bf16 a[160:163], v[40:43], a[96:99], a[160:163]
  ds_read_b64_tr_b16 a[92:93], v23 offset:16384
  v_xad_u32 v7, v54, s11, v7
  v_mfma_f32_16x16x32_bf16 a[176:179], v[40:43], a[112:115], a[176:179]
  v_rcp_f32 v64, v64
  v_mfma_f32_16x16x32_bf16 a[164:167], v[40:43], a[100:103], a[164:167]
  v_rcp_f32 v65, v65
  v_mfma_f32_16x16x32_bf16 a[180:183], v[40:43], a[116:119], a[180:183]
  v_rcp_f32 v66, v66
  v_mfma_f32_16x16x32_bf16 a[168:171], v[40:43], a[104:107], a[168:171]
  v_cvt_pk_bf16_f32 v44, v64, v65
  v_rcp_f32 v67, v67
  v_mfma_f32_16x16x32_bf16 a[184:187], v[40:43], a[120:123], a[184:187]
  v_rcp_f32 v68, v68
  v_mfma_f32_16x16x32_bf16 a[172:175], v[40:43], a[108:111], a[172:175]
  v_cvt_pk_bf16_f32 v45, v66, v67
  v_rcp_f32 v69, v69
  v_mfma_f32_16x16x32_bf16 a[188:191], v[40:43], a[124:127], a[188:191]
  v_rcp_f32 v70, v70
  v_mfma_f32_32x32x16_bf16 v[112:127], v[240:243], a[16:19], v[112:127]
  v_cvt_pk_bf16_f32 v46, v68, v69
  v_rcp_f32 v71, v71
  v_rcp_f32 v72, v72
  buffer_load_dwordx4 v7, s[36:39], 0 offen offset:3072 nt lds
  v_mfma_f32_32x32x16_bf16 v[112:127], v[244:247], a[20:23], v[112:127]
  v_cvt_pk_bf16_f32 v47, v70, v71
  v_rcp_f32 v73, v73
  ds_read_b64_tr_b16 a[94:95], v23 offset:16896
  v_rcp_f32 v74, v74
  v_mfma_f32_16x16x32_bf16 v[32:35], v[44:47], a[128:131], v[28:31]
  v_cvt_pk_bf16_f32 v48, v72, v73
  v_rcp_f32 v75, v75
  v_mfma_f32_32x32x16_bf16 v[112:127], v[248:251], a[24:27], v[112:127]
  v_rcp_f32 v76, v76
  v_cvt_pk_bf16_f32 v49, v74, v75
  v_rcp_f32 v77, v77
  v_rcp_f32 v78, v78
  v_mfma_f32_32x32x16_bf16 v[112:127], v[252:255], a[28:31], v[112:127]
  v_cvt_pk_bf16_f32 v50, v76, v77
  v_rcp_f32 v79, v79
  v_exp_f32 v80, v80
  v_exp_f32 v81, v81
  v_mfma_f32_32x32x16_bf16 v[112:127], v[60:63], a[198:201], v[112:127]
  v_cvt_pk_bf16_f32 v51, v78, v79
  v_exp_f32 v82, v82
  v_exp_f32 v83, v83
  v_exp_f32 v84, v84
  v_mfma_f32_16x16x32_bf16 v[32:35], v[48:51], a[132:135], v[32:35]
  v_exp_f32 v85, v85
  v_exp_f32 v86, v86
  v_exp_f32 v87, v87
  v_exp_f32 v88, v88
  v_exp_f32 v89, v89
  v_exp_f32 v90, v90
  v_exp_f32 v91, v91
  v_exp_f32 v92, v92
  v_exp_f32 v93, v93
  v_exp_f32 v94, v94
  v_exp_f32 v95, v95
  s_waitcnt vmcnt(8)
  ds_read_b128 a[32:35], v8 offset:24576
  v_exp_f32 v96, v96
  ds_read_b128 a[36:39], v9 offset:24576
  v_mfma_f32_32x32x16_bf16 v[80:95], a[192:195], a[196:199], v[80:95]
  ds_read_b128 a[40:43], v10 offset:24576
  v_exp_f32 v97, v97
  ds_read_b128 a[44:47], v11 offset:24576
  v_exp_f32 v98, v98
  ds_read_b128 a[48:51], v12 offset:24576
  v_exp_f32 v99, v99
  ds_read_b128 a[52:55], v13 offset:24576
  v_exp_f32 v100, v100
  ds_read_b128 a[56:59], v14 offset:24576
  v_exp_f32 v101, v101
  ds_read_b128 a[60:63], v15 offset:24576
  v_exp_f32 v102, v102
  v_rcp_f32 v80, v80
  v_rcp_f32 v81, v81
  v_rcp_f32 v82, v82
  v_rcp_f32 v83, v83
  v_cvt_pk_bf16_f32 v44, v80, v81
  v_rcp_f32 v84, v84
  s_waitcnt lgkmcnt(7)
  v_mfma_f32_32x32x16_bf16 v[64:79], v[128:131], a[32:35], 0
  v_cvt_pk_bf16_f32 v45, v82, v83
  v_rcp_f32 v85, v85
  v_rcp_f32 v86, v86
  v_rcp_f32 v87, v87
  s_waitcnt lgkmcnt(6)
  v_mfma_f32_32x32x16_bf16 v[64:79], v[132:135], a[36:39], v[64:79]
  v_cvt_pk_bf16_f32 v46, v84, v85
  v_rcp_f32 v88, v88
  v_cvt_pk_bf16_f32 v47, v86, v87
  v_rcp_f32 v89, v89
  s_waitcnt lgkmcnt(5)
  v_mfma_f32_32x32x16_bf16 v[64:79], v[136:139], a[40:43], v[64:79]
  v_rcp_f32 v90, v90
  v_cvt_pk_bf16_f32 v48, v88, v89
  v_rcp_f32 v91, v91
  v_rcp_f32 v92, v92
  v_mfma_f32_16x16x32_bf16 v[32:35], v[44:47], a[136:139], v[32:35]
  v_cvt_pk_bf16_f32 v49, v90, v91
  v_rcp_f32 v93, v93
  s_waitcnt lgkmcnt(4)
  v_mfma_f32_32x32x16_bf16 v[64:79], v[140:143], a[44:47], v[64:79]
  v_rcp_f32 v94, v94
  v_cvt_pk_bf16_f32 v50, v92, v93
  v_rcp_f32 v95, v95
  ds_read_b128 v[36:39], v52 offset:4352
  s_waitcnt lgkmcnt(4)
  v_mfma_f32_32x32x16_bf16 v[64:79], v[144:147], a[48:51], v[64:79]
  v_cvt_pk_bf16_f32 v51, v94, v95
  v_exp_f32 v103, v103
  v_exp_f32 v104, v104
  v_exp_f32 v105, v105
  v_mfma_f32_16x16x32_bf16 v[32:35], v[48:51], a[140:143], v[32:35]
  v_exp_f32 v106, v106
  s_waitcnt lgkmcnt(3)
  v_mfma_f32_32x32x16_bf16 v[64:79], v[148:151], a[52:55], v[64:79]
  v_exp_f32 v107, v107
  v_exp_f32 v108, v108
  v_exp_f32 v109, v109
  s_waitcnt lgkmcnt(2)
  v_mfma_f32_32x32x16_bf16 v[64:79], v[152:155], a[56:59], v[64:79]
  v_exp_f32 v110, v110
  v_exp_f32 v111, v111
  ds_read_b64_tr_b16 a[96:97], v16 offset:24576
  ds_read_b64_tr_b16 a[98:99], v16 offset:25088
  s_waitcnt lgkmcnt(3)
  v_mfma_f32_32x32x16_bf16 v[64:79], v[156:159], a[60:63], v[64:79]
  ds_read_b64_tr_b16 a[100:101], v17 offset:24576
  ds_read_b64_tr_b16 a[102:103], v17 offset:25088
  ds_read_b64_tr_b16 a[104:105], v18 offset:24576
  ds_read_b64_tr_b16 a[106:107], v18 offset:25088
  v_mfma_f32_32x32x16_bf16 v[96:111], a[192:195], a[196:199], v[96:111]
  v_exp_f32 v112, v112
  v_exp_f32 v113, v113
  v_exp_f32 v114, v114
  v_mfma_f32_32x32x16_bf16 v[64:79], v[60:63], a[196:199], v[64:79]
  v_exp_f32 v115, v115
  v_exp_f32 v116, v116
  v_exp_f32 v117, v117
  v_mfma_f32_32x32x16_bf16 v[80:95], v[160:163], a[32:35], 0
  v_exp_f32 v118, v118
  v_exp_f32 v119, v119
  v_exp_f32 v120, v120
  v_mfma_f32_32x32x16_bf16 v[80:95], v[164:167], a[36:39], v[80:95]
  v_rcp_f32 v96, v96
  v_rcp_f32 v97, v97
  v_rcp_f32 v98, v98
  v_mfma_f32_32x32x16_bf16 v[80:95], v[168:171], a[40:43], v[80:95]
  v_cvt_pk_bf16_f32 v44, v96, v97
  v_rcp_f32 v99, v99
  v_rcp_f32 v100, v100
  v_rcp_f32 v101, v101
  v_mfma_f32_32x32x16_bf16 v[80:95], v[172:175], a[44:47], v[80:95]
  v_cvt_pk_bf16_f32 v45, v98, v99
  v_rcp_f32 v102, v102
  v_cvt_pk_bf16_f32 v46, v100, v101
  v_rcp_f32 v103, v103
  v_mfma_f32_32x32x16_bf16 v[80:95], v[176:179], a[48:51], v[80:95]
  v_rcp_f32 v104, v104
  v_cvt_pk_bf16_f32 v47, v102, v103
  v_rcp_f32 v105, v105
  v_rcp_f32 v106, v106
  v_mfma_f32_16x16x32_bf16 v[32:35], v[44:47], a[144:147], v[32:35]
  v_cvt_pk_bf16_f32 v48, v104, v105
  v_rcp_f32 v107, v107
  v_mfma_f32_32x32x16_bf16 v[80:95], v[180:183], a[52:55], v[80:95]
  v_rcp_f32 v108, v108
  v_cvt_pk_bf16_f32 v49, v106, v107
  v_rcp_f32 v109, v109
  v_rcp_f32 v110, v110
  v_mfma_f32_32x32x16_bf16 v[80:95], v[184:187], a[56:59], v[80:95]
  v_cvt_pk_bf16_f32 v50, v108, v109
  v_rcp_f32 v111, v111
  v_exp_f32 v121, v121
  v_exp_f32 v122, v122
  v_mfma_f32_32x32x16_bf16 v[80:95], v[188:191], a[60:63], v[80:95]
  v_cvt_pk_bf16_f32 v51, v110, v111
  v_exp_f32 v123, v123
  v_exp_f32 v124, v124
  v_exp_f32 v125, v125
  v_mfma_f32_16x16x32_bf16 v[32:35], v[48:51], a[148:151], v[32:35]
  v_exp_f32 v126, v126
  v_mfma_f32_32x32x16_bf16 v[80:95], v[60:63], a[200:203], v[80:95]
  v_exp_f32 v127, v127
  ds_read_b64_tr_b16 a[108:109], v19 offset:24576
  ds_read_b64_tr_b16 a[110:111], v19 offset:25088
  ds_read_b64_tr_b16 a[112:113], v20 offset:24576
  v_mfma_f32_32x32x16_bf16 v[112:127], a[192:195], a[196:199], v[112:127]
  ds_read_b64_tr_b16 a[114:115], v20 offset:25088
  ds_read_b64_tr_b16 a[116:117], v21 offset:24576
  v_exp_f32 v64, v64
  v_exp_f32 v65, v65
  v_mfma_f32_32x32x16_bf16 v[96:111], v[192:195], a[32:35], 0
  v_exp_f32 v66, v66
  v_exp_f32 v67, v67
  v_exp_f32 v68, v68
  v_mfma_f32_32x32x16_bf16 v[96:111], v[196:199], a[36:39], v[96:111]
  v_exp_f32 v69, v69
  v_exp_f32 v70, v70
  v_exp_f32 v71, v71
  v_mfma_f32_32x32x16_bf16 v[96:111], v[200:203], a[40:43], v[96:111]
  v_rcp_f32 v112, v112
  v_rcp_f32 v113, v113
  v_rcp_f32 v114, v114
  v_mfma_f32_32x32x16_bf16 v[96:111], v[204:207], a[44:47], v[96:111]
  v_cvt_pk_bf16_f32 v44, v112, v113
  v_rcp_f32 v115, v115
  v_rcp_f32 v116, v116
  v_rcp_f32 v117, v117
  v_mfma_f32_32x32x16_bf16 v[96:111], v[208:211], a[48:51], v[96:111]
  v_cvt_pk_bf16_f32 v45, v114, v115
  v_rcp_f32 v118, v118
  v_cvt_pk_bf16_f32 v46, v116, v117
  v_rcp_f32 v119, v119
  v_mfma_f32_32x32x16_bf16 v[96:111], v[212:215], a[52:55], v[96:111]
  v_rcp_f32 v120, v120
  v_cvt_pk_bf16_f32 v47, v118, v119
  v_rcp_f32 v121, v121
  v_rcp_f32 v122, v122
  v_mfma_f32_16x16x32_bf16 v[32:35], v[44:47], a[152:155], v[32:35]
  v_cvt_pk_bf16_f32 v48, v120, v121
  v_rcp_f32 v123, v123
  v_mfma_f32_32x32x16_bf16 v[96:111], v[216:219], a[56:59], v[96:111]
  v_rcp_f32 v124, v124
  v_cvt_pk_bf16_f32 v49, v122, v123
  v_rcp_f32 v125, v125
  v_rcp_f32 v126, v126
  v_mfma_f32_32x32x16_bf16 v[96:111], v[220:223], a[60:63], v[96:111]
  v_cvt_pk_bf16_f32 v50, v124, v125
  v_rcp_f32 v127, v127
  v_exp_f32 v72, v72
  v_exp_f32 v73, v73
  v_mfma_f32_32x32x16_bf16 v[96:111], v[60:63], a[194:197], v[96:111]
  v_cvt_pk_bf16_f32 v51, v126, v127
  v_exp_f32 v74, v74
  v_exp_f32 v75, v75
  v_exp_f32 v76, v76
  v_mfma_f32_16x16x32_bf16 v[32:35], v[48:51], a[156:159], v[32:35]
  v_exp_f32 v77, v77
  v_mfma_f32_32x32x16_bf16 v[112:127], v[224:227], a[32:35], 0
  v_exp_f32 v78, v78
  v_exp_f32 v79, v79
  ds_read_b64_tr_b16 a[118:119], v21 offset:25088
  ds_read_b64_tr_b16 a[120:121], v22 offset:24576
  v_mfma_f32_32x32x16_bf16 v[112:127], v[228:231], a[36:39], v[112:127]
  ds_read_b64_tr_b16 a[122:123], v22 offset:25088
  s_waitcnt lgkmcnt(14)
  v_mul_legacy_f32 v32, v32, v36
  v_mul_legacy_f32 v33, v33, v37
  v_mul_legacy_f32 v34, v34, v38
  v_mul_legacy_f32 v35, v35, v39
  v_cvt_pk_bf16_f32 v40, v32, v33
  v_mfma_f32_32x32x16_bf16 v[64:79], a[192:195], a[196:199], v[64:79]
  v_cvt_pk_bf16_f32 v41, v34, v35
  v_mov_b32_dpp v42, v40 quad_perm:[1,0,3,2] row_mask:0xf bank_mask:0xf
  ds_read_b64_tr_b16 a[124:125], v23 offset:24576
  v_mov_b32_dpp v43, v41 quad_perm:[1,0,3,2] row_mask:0xf bank_mask:0xf
  ds_read_b64_tr_b16 a[126:127], v23 offset:25088
  v_mfma_f32_32x32x16_bf16 v[112:127], v[232:235], a[40:43], v[112:127]
  v_exp_f32 v80, v80
  v_exp_f32 v81, v81
  v_exp_f32 v82, v82
  v_mfma_f32_16x16x32_bf16 a[160:163], v[40:43], a[64:67], a[160:163]
  v_exp_f32 v83, v83
  v_mfma_f32_16x16x32_bf16 a[176:179], v[40:43], a[80:83], a[176:179]
  v_rcp_f32 v64, v64
  v_mfma_f32_16x16x32_bf16 a[164:167], v[40:43], a[68:71], a[164:167]
  v_rcp_f32 v65, v65
  v_mfma_f32_16x16x32_bf16 a[180:183], v[40:43], a[84:87], a[180:183]
  v_rcp_f32 v66, v66
  v_mfma_f32_16x16x32_bf16 a[168:171], v[40:43], a[72:75], a[168:171]
  v_cvt_pk_bf16_f32 v44, v64, v65
  v_rcp_f32 v67, v67
  v_mfma_f32_16x16x32_bf16 a[184:187], v[40:43], a[88:91], a[184:187]
  v_rcp_f32 v68, v68
  v_mfma_f32_16x16x32_bf16 a[172:175], v[40:43], a[76:79], a[172:175]
  v_cvt_pk_bf16_f32 v45, v66, v67
  v_rcp_f32 v69, v69
  v_mfma_f32_16x16x32_bf16 a[188:191], v[40:43], a[92:95], a[188:191]
  v_rcp_f32 v70, v70
  v_mfma_f32_32x32x16_bf16 v[112:127], v[236:239], a[44:47], v[112:127]
  v_cvt_pk_bf16_f32 v46, v68, v69
  v_rcp_f32 v71, v71
  v_rcp_f32 v72, v72
  v_rcp_f32 v73, v73
  v_mfma_f32_32x32x16_bf16 v[112:127], v[240:243], a[48:51], v[112:127]
  v_cvt_pk_bf16_f32 v47, v70, v71
  v_rcp_f32 v74, v74
  v_cvt_pk_bf16_f32 v48, v72, v73
  v_rcp_f32 v75, v75
  v_mfma_f32_16x16x32_bf16 v[32:35], v[44:47], a[128:131], v[28:31]
  v_rcp_f32 v76, v76
  v_mfma_f32_32x32x16_bf16 v[112:127], v[244:247], a[52:55], v[112:127]
  v_cvt_pk_bf16_f32 v49, v74, v75
  v_rcp_f32 v77, v77
  v_rcp_f32 v78, v78
  v_rcp_f32 v79, v79
  v_mfma_f32_32x32x16_bf16 v[112:127], v[248:251], a[56:59], v[112:127]
  v_cvt_pk_bf16_f32 v50, v76, v77
  v_exp_f32 v84, v84
  v_cvt_pk_bf16_f32 v51, v78, v79
  v_exp_f32 v85, v85
  v_mfma_f32_32x32x16_bf16 v[112:127], v[252:255], a[60:63], v[112:127]
  v_exp_f32 v86, v86
  v_exp_f32 v87, v87
  v_exp_f32 v88, v88
  v_mfma_f32_16x16x32_bf16 v[32:35], v[48:51], a[132:135], v[32:35]
  v_exp_f32 v89, v89
  v_mfma_f32_32x32x16_bf16 v[112:127], v[60:63], a[198:201], v[112:127]
  v_exp_f32 v90, v90
  v_exp_f32 v91, v91
  v_exp_f32 v92, v92
  v_exp_f32 v93, v93
  v_exp_f32 v94, v94
  v_exp_f32 v95, v95
  s_waitcnt vmcnt(0)
  ds_read_b128 a[0:3], v8 offset:0
  v_exp_f32 v96, v96
  ds_read_b128 a[4:7], v9 offset:0
  v_mfma_f32_32x32x16_bf16 v[80:95], a[192:195], a[196:199], v[80:95]
  ds_read_b128 a[8:11], v10 offset:0
  v_exp_f32 v97, v97
  ds_read_b128 a[12:15], v11 offset:0
  v_exp_f32 v98, v98
  ds_read_b128 a[16:19], v12 offset:0
  v_exp_f32 v99, v99
  ds_read_b128 a[20:23], v13 offset:0
  v_exp_f32 v100, v100
  ds_read_b128 a[24:27], v14 offset:0
  v_exp_f32 v101, v101
  ds_read_b128 a[28:31], v15 offset:0
  v_exp_f32 v102, v102
  v_rcp_f32 v80, v80
  v_rcp_f32 v81, v81
  v_rcp_f32 v82, v82
  v_rcp_f32 v83, v83
  v_cvt_pk_bf16_f32 v44, v80, v81
  v_rcp_f32 v84, v84
  s_waitcnt lgkmcnt(7)
  v_mfma_f32_32x32x16_bf16 v[64:79], v[128:131], a[0:3], 0
  v_cvt_pk_bf16_f32 v45, v82, v83
  v_rcp_f32 v85, v85
  v_rcp_f32 v86, v86
  v_rcp_f32 v87, v87
  s_waitcnt lgkmcnt(6)
  v_mfma_f32_32x32x16_bf16 v[64:79], v[132:135], a[4:7], v[64:79]
  v_cvt_pk_bf16_f32 v46, v84, v85
  v_rcp_f32 v88, v88
  v_cvt_pk_bf16_f32 v47, v86, v87
  v_rcp_f32 v89, v89
  s_waitcnt lgkmcnt(5)
  v_mfma_f32_32x32x16_bf16 v[64:79], v[136:139], a[8:11], v[64:79]
  v_rcp_f32 v90, v90
  v_cvt_pk_bf16_f32 v48, v88, v89
  v_rcp_f32 v91, v91
  v_rcp_f32 v92, v92
  v_mfma_f32_16x16x32_bf16 v[32:35], v[44:47], a[136:139], v[32:35]
  v_cvt_pk_bf16_f32 v49, v90, v91
  v_rcp_f32 v93, v93
  s_waitcnt lgkmcnt(4)
  v_mfma_f32_32x32x16_bf16 v[64:79], v[140:143], a[12:15], v[64:79]
  v_rcp_f32 v94, v94
  v_cvt_pk_bf16_f32 v50, v92, v93
  v_rcp_f32 v95, v95
  ds_read_b128 v[36:39], v52 offset:4480
  s_waitcnt lgkmcnt(4)
  v_mfma_f32_32x32x16_bf16 v[64:79], v[144:147], a[16:19], v[64:79]
  v_cvt_pk_bf16_f32 v51, v94, v95
  v_exp_f32 v103, v103
  v_exp_f32 v104, v104
  v_exp_f32 v105, v105
  v_mfma_f32_16x16x32_bf16 v[32:35], v[48:51], a[140:143], v[32:35]
  v_exp_f32 v106, v106
  s_waitcnt lgkmcnt(3)
  v_mfma_f32_32x32x16_bf16 v[64:79], v[148:151], a[20:23], v[64:79]
  v_exp_f32 v107, v107
  v_exp_f32 v108, v108
  v_exp_f32 v109, v109
  s_waitcnt lgkmcnt(2)
  v_mfma_f32_32x32x16_bf16 v[64:79], v[152:155], a[24:27], v[64:79]
  v_exp_f32 v110, v110
  v_exp_f32 v111, v111
  ds_read_b64_tr_b16 a[64:65], v16 offset:0
  ds_read_b64_tr_b16 a[66:67], v16 offset:512
  s_waitcnt lgkmcnt(3)
  v_mfma_f32_32x32x16_bf16 v[64:79], v[156:159], a[28:31], v[64:79]
  ds_read_b64_tr_b16 a[68:69], v17 offset:0
  ds_read_b64_tr_b16 a[70:71], v17 offset:512
  ds_read_b64_tr_b16 a[72:73], v18 offset:0
  ds_read_b64_tr_b16 a[74:75], v18 offset:512
  v_mfma_f32_32x32x16_bf16 v[96:111], a[192:195], a[196:199], v[96:111]
  v_exp_f32 v112, v112
  v_exp_f32 v113, v113
  v_exp_f32 v114, v114
  v_mfma_f32_32x32x16_bf16 v[64:79], v[60:63], a[196:199], v[64:79]
  v_exp_f32 v115, v115
  v_exp_f32 v116, v116
  v_exp_f32 v117, v117
  v_mfma_f32_32x32x16_bf16 v[80:95], v[160:163], a[0:3], 0
  v_exp_f32 v118, v118
  v_exp_f32 v119, v119
  v_exp_f32 v120, v120
  v_mfma_f32_32x32x16_bf16 v[80:95], v[164:167], a[4:7], v[80:95]
  v_rcp_f32 v96, v96
  v_rcp_f32 v97, v97
  v_rcp_f32 v98, v98
  v_mfma_f32_32x32x16_bf16 v[80:95], v[168:171], a[8:11], v[80:95]
  v_cvt_pk_bf16_f32 v44, v96, v97
  v_rcp_f32 v99, v99
  v_rcp_f32 v100, v100
  v_rcp_f32 v101, v101
  v_mfma_f32_32x32x16_bf16 v[80:95], v[172:175], a[12:15], v[80:95]
  v_cvt_pk_bf16_f32 v45, v98, v99
  v_rcp_f32 v102, v102
  v_cvt_pk_bf16_f32 v46, v100, v101
  v_rcp_f32 v103, v103
  v_mfma_f32_32x32x16_bf16 v[80:95], v[176:179], a[16:19], v[80:95]
  v_rcp_f32 v104, v104
  v_cvt_pk_bf16_f32 v47, v102, v103
  v_rcp_f32 v105, v105
  v_rcp_f32 v106, v106
  v_mfma_f32_16x16x32_bf16 v[32:35], v[44:47], a[144:147], v[32:35]
  v_cvt_pk_bf16_f32 v48, v104, v105
  v_rcp_f32 v107, v107
  v_mfma_f32_32x32x16_bf16 v[80:95], v[180:183], a[20:23], v[80:95]
  v_rcp_f32 v108, v108
  v_cvt_pk_bf16_f32 v49, v106, v107
  v_rcp_f32 v109, v109
  v_rcp_f32 v110, v110
  v_mfma_f32_32x32x16_bf16 v[80:95], v[184:187], a[24:27], v[80:95]
  v_cvt_pk_bf16_f32 v50, v108, v109
  v_rcp_f32 v111, v111
  v_exp_f32 v121, v121
  v_exp_f32 v122, v122
  v_mfma_f32_32x32x16_bf16 v[80:95], v[188:191], a[28:31], v[80:95]
  v_cvt_pk_bf16_f32 v51, v110, v111
  v_exp_f32 v123, v123
  v_exp_f32 v124, v124
  v_exp_f32 v125, v125
  v_mfma_f32_16x16x32_bf16 v[32:35], v[48:51], a[148:151], v[32:35]
  v_exp_f32 v126, v126
  v_mfma_f32_32x32x16_bf16 v[80:95], v[60:63], a[200:203], v[80:95]
  v_exp_f32 v127, v127
  ds_read_b64_tr_b16 a[76:77], v19 offset:0
  ds_read_b64_tr_b16 a[78:79], v19 offset:512
  ds_read_b64_tr_b16 a[80:81], v20 offset:0
  v_mfma_f32_32x32x16_bf16 v[112:127], a[192:195], a[196:199], v[112:127]
  ds_read_b64_tr_b16 a[82:83], v20 offset:512
  ds_read_b64_tr_b16 a[84:85], v21 offset:0
  v_exp_f32 v64, v64
  v_exp_f32 v65, v65
  v_mfma_f32_32x32x16_bf16 v[96:111], v[192:195], a[0:3], 0
  v_exp_f32 v66, v66
  v_exp_f32 v67, v67
  v_exp_f32 v68, v68
  v_mfma_f32_32x32x16_bf16 v[96:111], v[196:199], a[4:7], v[96:111]
  v_exp_f32 v69, v69
  v_exp_f32 v70, v70
  v_exp_f32 v71, v71
  v_mfma_f32_32x32x16_bf16 v[96:111], v[200:203], a[8:11], v[96:111]
  v_rcp_f32 v112, v112
  v_rcp_f32 v113, v113
  v_rcp_f32 v114, v114
  v_mfma_f32_32x32x16_bf16 v[96:111], v[204:207], a[12:15], v[96:111]
  v_cvt_pk_bf16_f32 v44, v112, v113
  v_rcp_f32 v115, v115
  v_rcp_f32 v116, v116
  v_rcp_f32 v117, v117
  v_mfma_f32_32x32x16_bf16 v[96:111], v[208:211], a[16:19], v[96:111]
  v_cvt_pk_bf16_f32 v45, v114, v115
  v_rcp_f32 v118, v118
  v_cvt_pk_bf16_f32 v46, v116, v117
  v_rcp_f32 v119, v119
  v_mfma_f32_32x32x16_bf16 v[96:111], v[212:215], a[20:23], v[96:111]
  v_rcp_f32 v120, v120
  v_cvt_pk_bf16_f32 v47, v118, v119
  v_rcp_f32 v121, v121
  v_rcp_f32 v122, v122
  v_mfma_f32_16x16x32_bf16 v[32:35], v[44:47], a[152:155], v[32:35]
  v_cvt_pk_bf16_f32 v48, v120, v121
  v_rcp_f32 v123, v123
  v_mfma_f32_32x32x16_bf16 v[96:111], v[216:219], a[24:27], v[96:111]
  v_rcp_f32 v124, v124
  v_cvt_pk_bf16_f32 v49, v122, v123
  v_rcp_f32 v125, v125
  v_rcp_f32 v126, v126
  v_mfma_f32_32x32x16_bf16 v[96:111], v[220:223], a[28:31], v[96:111]
  v_cvt_pk_bf16_f32 v50, v124, v125
  v_rcp_f32 v127, v127
  v_exp_f32 v72, v72
  v_exp_f32 v73, v73
  v_mfma_f32_32x32x16_bf16 v[96:111], v[60:63], a[194:197], v[96:111]
  v_cvt_pk_bf16_f32 v51, v126, v127
  v_exp_f32 v74, v74
  v_exp_f32 v75, v75
  v_exp_f32 v76, v76
  v_mfma_f32_16x16x32_bf16 v[32:35], v[48:51], a[156:159], v[32:35]
  v_exp_f32 v77, v77
  v_mfma_f32_32x32x16_bf16 v[112:127], v[224:227], a[0:3], 0
  v_exp_f32 v78, v78
  v_exp_f32 v79, v79
  ds_read_b64_tr_b16 a[86:87], v21 offset:512
  ds_read_b64_tr_b16 a[88:89], v22 offset:0
  v_mfma_f32_32x32x16_bf16 v[112:127], v[228:231], a[4:7], v[112:127]
  ds_read_b64_tr_b16 a[90:91], v22 offset:512
  s_waitcnt lgkmcnt(14)
  v_mul_legacy_f32 v32, v32, v36
  v_mul_legacy_f32 v33, v33, v37
  v_mul_legacy_f32 v34, v34, v38
  v_mul_legacy_f32 v35, v35, v39
  v_cvt_pk_bf16_f32 v40, v32, v33
  v_mfma_f32_32x32x16_bf16 v[64:79], a[192:195], a[196:199], v[64:79]
  v_cvt_pk_bf16_f32 v41, v34, v35
  v_mov_b32_dpp v42, v40 quad_perm:[1,0,3,2] row_mask:0xf bank_mask:0xf
  ds_read_b64_tr_b16 a[92:93], v23 offset:0
  v_mov_b32_dpp v43, v41 quad_perm:[1,0,3,2] row_mask:0xf bank_mask:0xf
  ds_read_b64_tr_b16 a[94:95], v23 offset:512
  v_mfma_f32_32x32x16_bf16 v[112:127], v[232:235], a[8:11], v[112:127]
  v_exp_f32 v80, v80
  v_exp_f32 v81, v81
  v_exp_f32 v82, v82
  v_mfma_f32_16x16x32_bf16 a[160:163], v[40:43], a[96:99], a[160:163]
  v_exp_f32 v83, v83
  v_mfma_f32_16x16x32_bf16 a[176:179], v[40:43], a[112:115], a[176:179]
  v_rcp_f32 v64, v64
  v_mfma_f32_16x16x32_bf16 a[164:167], v[40:43], a[100:103], a[164:167]
  v_rcp_f32 v65, v65
  v_mfma_f32_16x16x32_bf16 a[180:183], v[40:43], a[116:119], a[180:183]
  v_rcp_f32 v66, v66
  v_mfma_f32_16x16x32_bf16 a[168:171], v[40:43], a[104:107], a[168:171]
  v_cvt_pk_bf16_f32 v44, v64, v65
  v_rcp_f32 v67, v67
  v_mfma_f32_16x16x32_bf16 a[184:187], v[40:43], a[120:123], a[184:187]
  v_rcp_f32 v68, v68
  v_mfma_f32_16x16x32_bf16 a[172:175], v[40:43], a[108:111], a[172:175]
  v_cvt_pk_bf16_f32 v45, v66, v67
  v_rcp_f32 v69, v69
  v_mfma_f32_16x16x32_bf16 a[188:191], v[40:43], a[124:127], a[188:191]
  v_rcp_f32 v70, v70
  v_mfma_f32_32x32x16_bf16 v[112:127], v[236:239], a[12:15], v[112:127]
  v_cvt_pk_bf16_f32 v46, v68, v69
  v_rcp_f32 v71, v71
  v_rcp_f32 v72, v72
  v_rcp_f32 v73, v73
  v_mfma_f32_32x32x16_bf16 v[112:127], v[240:243], a[16:19], v[112:127]
  v_cvt_pk_bf16_f32 v47, v70, v71
  v_rcp_f32 v74, v74
  v_cvt_pk_bf16_f32 v48, v72, v73
  v_rcp_f32 v75, v75
  v_mfma_f32_16x16x32_bf16 v[32:35], v[44:47], a[128:131], v[28:31]
  v_rcp_f32 v76, v76
  v_mfma_f32_32x32x16_bf16 v[112:127], v[244:247], a[20:23], v[112:127]
  v_cvt_pk_bf16_f32 v49, v74, v75
  v_rcp_f32 v77, v77
  v_rcp_f32 v78, v78
  v_rcp_f32 v79, v79
  v_mfma_f32_32x32x16_bf16 v[112:127], v[248:251], a[24:27], v[112:127]
  v_cvt_pk_bf16_f32 v50, v76, v77
  v_exp_f32 v84, v84
  v_cvt_pk_bf16_f32 v51, v78, v79
  v_exp_f32 v85, v85
  v_mfma_f32_32x32x16_bf16 v[112:127], v[252:255], a[28:31], v[112:127]
  v_exp_f32 v86, v86
  v_exp_f32 v87, v87
  v_exp_f32 v88, v88
  v_mfma_f32_16x16x32_bf16 v[32:35], v[48:51], a[132:135], v[32:35]
  v_exp_f32 v89, v89
  v_mfma_f32_32x32x16_bf16 v[112:127], v[60:63], a[198:201], v[112:127]
  v_exp_f32 v90, v90
  v_exp_f32 v91, v91
  v_exp_f32 v92, v92
  v_exp_f32 v93, v93
  v_exp_f32 v94, v94
  v_exp_f32 v95, v95
  ds_read_b128 v[36:39], v52 offset:4608
  v_exp_f32 v96, v96
  v_exp_f32 v97, v97
  v_mfma_f32_32x32x16_bf16 v[80:95], a[192:195], a[196:199], v[80:95]
  v_exp_f32 v98, v98
  v_exp_f32 v99, v99
  v_exp_f32 v100, v100
  v_exp_f32 v101, v101
  v_exp_f32 v102, v102
  v_exp_f32 v103, v103
  v_exp_f32 v104, v104
  v_exp_f32 v105, v105
  v_exp_f32 v106, v106
  v_exp_f32 v107, v107
  v_exp_f32 v108, v108
  v_exp_f32 v109, v109
  v_exp_f32 v110, v110
  v_exp_f32 v111, v111
  v_rcp_f32 v80, v80
  v_rcp_f32 v81, v81
  v_rcp_f32 v82, v82
  v_mfma_f32_32x32x16_bf16 v[96:111], a[192:195], a[196:199], v[96:111]
  v_cvt_pk_bf16_f32 v44, v80, v81
  v_rcp_f32 v83, v83
  v_rcp_f32 v84, v84
  v_rcp_f32 v85, v85
  v_cvt_pk_bf16_f32 v45, v82, v83
  v_rcp_f32 v86, v86
  v_rcp_f32 v87, v87
  v_cvt_pk_bf16_f32 v46, v84, v85
  v_rcp_f32 v88, v88
  v_rcp_f32 v89, v89
  v_cvt_pk_bf16_f32 v47, v86, v87
  v_rcp_f32 v90, v90
  v_rcp_f32 v91, v91
  v_mfma_f32_16x16x32_bf16 v[32:35], v[44:47], a[136:139], v[32:35]
  v_cvt_pk_bf16_f32 v48, v88, v89
  v_rcp_f32 v92, v92
  v_cvt_pk_bf16_f32 v49, v90, v91
  v_rcp_f32 v93, v93
  v_rcp_f32 v94, v94
  v_rcp_f32 v95, v95
  v_cvt_pk_bf16_f32 v50, v92, v93
  v_exp_f32 v112, v112
  v_exp_f32 v113, v113
  v_cvt_pk_bf16_f32 v51, v94, v95
  v_exp_f32 v114, v114
  v_exp_f32 v115, v115
  v_mfma_f32_16x16x32_bf16 v[32:35], v[48:51], a[140:143], v[32:35]
  v_exp_f32 v116, v116
  v_exp_f32 v117, v117
  v_exp_f32 v118, v118
  v_exp_f32 v119, v119
  v_exp_f32 v120, v120
  v_exp_f32 v121, v121
  v_exp_f32 v122, v122
  v_exp_f32 v123, v123
  v_exp_f32 v124, v124
  v_exp_f32 v125, v125
  v_exp_f32 v126, v126
  v_exp_f32 v127, v127
  v_rcp_f32 v96, v96
  v_rcp_f32 v97, v97
  v_rcp_f32 v98, v98
  v_mfma_f32_32x32x16_bf16 v[112:127], a[192:195], a[196:199], v[112:127]
  v_cvt_pk_bf16_f32 v44, v96, v97
  v_rcp_f32 v99, v99
  v_rcp_f32 v100, v100
  v_rcp_f32 v101, v101
  v_cvt_pk_bf16_f32 v45, v98, v99
  v_rcp_f32 v102, v102
  v_rcp_f32 v103, v103
  v_cvt_pk_bf16_f32 v46, v100, v101
  v_rcp_f32 v104, v104
  v_rcp_f32 v105, v105
  v_cvt_pk_bf16_f32 v47, v102, v103
  v_rcp_f32 v106, v106
  v_rcp_f32 v107, v107
  v_mfma_f32_16x16x32_bf16 v[32:35], v[44:47], a[144:147], v[32:35]
  v_cvt_pk_bf16_f32 v48, v104, v105
  v_rcp_f32 v108, v108
  v_cvt_pk_bf16_f32 v49, v106, v107
  v_rcp_f32 v109, v109
  v_rcp_f32 v110, v110
  v_rcp_f32 v111, v111
  v_cvt_pk_bf16_f32 v50, v108, v109
  v_rcp_f32 v112, v112
  v_rcp_f32 v113, v113
  v_cvt_pk_bf16_f32 v51, v110, v111
  v_rcp_f32 v114, v114
  v_rcp_f32 v115, v115
  v_mfma_f32_16x16x32_bf16 v[32:35], v[48:51], a[148:151], v[32:35]
  v_cvt_pk_bf16_f32 v44, v112, v113
  v_rcp_f32 v116, v116
  v_cvt_pk_bf16_f32 v45, v114, v115
  v_rcp_f32 v117, v117
  v_rcp_f32 v118, v118
  v_rcp_f32 v119, v119
  v_cvt_pk_bf16_f32 v46, v116, v117
  v_rcp_f32 v120, v120
  v_rcp_f32 v121, v121
  v_cvt_pk_bf16_f32 v47, v118, v119
  v_rcp_f32 v122, v122
  v_rcp_f32 v123, v123
  v_mfma_f32_16x16x32_bf16 v[32:35], v[44:47], a[152:155], v[32:35]
  v_cvt_pk_bf16_f32 v48, v120, v121
  v_rcp_f32 v124, v124
  v_cvt_pk_bf16_f32 v49, v122, v123
  v_rcp_f32 v125, v125
  v_rcp_f32 v126, v126
  v_rcp_f32 v127, v127
  v_cvt_pk_bf16_f32 v50, v124, v125
  v_mbcnt_lo_u32_b32 v66, -1, 0
  v_mbcnt_hi_u32_b32 v66, -1, v66
  v_cvt_pk_bf16_f32 v51, v126, v127
  v_lshlrev_b32 v66, 1, v66
  s_nop 0
  v_mfma_f32_16x16x32_bf16 v[32:35], v[48:51], a[156:159], v[32:35]
  s_waitcnt lgkmcnt(0)
  s_nop 6
  v_mul_legacy_f32 v32, v32, v36
  v_mul_legacy_f32 v33, v33, v37
  v_mul_legacy_f32 v34, v34, v38
  v_mul_legacy_f32 v35, v35, v39
  v_cvt_pk_bf16_f32 v40, v32, v33
  v_cvt_pk_bf16_f32 v41, v34, v35
  s_nop 0
  v_mov_b32_dpp v42, v40 quad_perm:[1,0,3,2] row_mask:0xf bank_mask:0xf
  v_mov_b32_dpp v43, v41 quad_perm:[1,0,3,2] row_mask:0xf bank_mask:0xf
  s_nop 1
  v_mfma_f32_16x16x32_bf16 a[160:163], v[40:43], a[64:67], a[160:163]
  v_mfma_f32_16x16x32_bf16 a[176:179], v[40:43], a[80:83], a[176:179]
  v_mfma_f32_16x16x32_bf16 a[164:167], v[40:43], a[68:71], a[164:167]
  v_mfma_f32_16x16x32_bf16 a[180:183], v[40:43], a[84:87], a[180:183]
  v_mfma_f32_16x16x32_bf16 a[168:171], v[40:43], a[72:75], a[168:171]
  v_mfma_f32_16x16x32_bf16 a[184:187], v[40:43], a[88:91], a[184:187]
  v_mfma_f32_16x16x32_bf16 a[172:175], v[40:43], a[76:79], a[172:175]
  v_mfma_f32_16x16x32_bf16 a[188:191], v[40:43], a[92:95], a[188:191]
  s_nop 0
  v_accvgpr_read_b32 v68, a160
  v_accvgpr_read_b32 v69, a176
  v_cvt_pk_bf16_f32 v64, v68, v69
  v_accvgpr_read_b32 v70, a164
  v_accvgpr_read_b32 v71, a180
  v_cvt_pk_bf16_f32 v70, v70, v71
  v_accvgpr_read_b32 v72, a168
  v_accvgpr_read_b32 v73, a184
  v_mov_b32_dpp v64, v70 quad_perm:[0,1,2,3] row_mask:0x2 bank_mask:0xf
  v_cvt_pk_bf16_f32 v72, v72, v73
  v_accvgpr_read_b32 v74, a172
  v_accvgpr_read_b32 v75, a188
  v_mov_b32_dpp v64, v72 quad_perm:[0,1,2,3] row_mask:0x4 bank_mask:0xf
  v_cvt_pk_bf16_f32 v74, v74, v75
  s_nop 1
  v_mov_b32_dpp v64, v74 quad_perm:[0,1,2,3] row_mask:0x8 bank_mask:0xf
  s_branch L_store
L_codeend:
L_t6:
  v_mfma_f32_32x32x16_bf16 v[112:127], v[224:227], a[32:35], 0
  s_waitcnt vmcnt(8)
  ds_read_b128 a[0:3], v8 offset:16384
  s_nop 1
  v_rcp_f32 v80, v80
  v_rcp_f32 v81, v81
  v_mfma_f32_32x32x16_bf16 v[112:127], v[228:231], a[36:39], v[112:127]
  ds_read_b128 v[0:3], v53 offset:512
  v_cvt_pk_bf16_f32 v44, v80, v81
  v_rcp_f32 v82, v82
  ds_read_b128 a[4:7], v9 offset:16384
  v_mfma_f32_32x32x16_bf16 v[112:127], v[232:235], a[40:43], v[112:127]
  v_rcp_f32 v83, v83
  v_rcp_f32 v84, v84
  v_rcp_f32 v85, v85
  v_mfma_f32_32x32x16_bf16 v[112:127], v[236:239], a[44:47], v[112:127]
  v_cvt_pk_bf16_f32 v45, v82, v83
  ds_read_b128 a[8:11], v10 offset:16384
  v_cvt_pk_bf16_f32 v46, v84, v85
  v_rcp_f32 v86, v86
  v_mfma_f32_32x32x16_bf16 v[112:127], v[240:243], a[48:51], v[112:127]
  v_rcp_f32 v87, v87
  v_rcp_f32 v88, v88
  ds_read_b128 a[12:15], v11 offset:16384
  v_cvt_pk_bf16_f32 v47, v86, v87
  v_mfma_f32_32x32x16_bf16 v[112:127], v[244:247], a[52:55], v[112:127]
  s_add_u32 m0, s14, 0
  v_rcp_f32 v89, v89
  ds_read_b128 a[16:19], v12 offset:16384
  v_rcp_f32 v90, v90
  v_mfma_f32_16x16x32_bf16 v[32:35], v[44:47], a[136:139], v[32:35]
  s_waitcnt lgkmcnt(4)
  v_xad_u32 v0, v54, 0, v0
  buffer_load_dwordx4 v0, s[36:39], s52 offen offset:0 nt lds
  v_mfma_f32_32x32x16_bf16 v[112:127], v[248:251], a[56:59], v[112:127]
  v_cvt_pk_bf16_f32 v48, v88, v89
  v_rcp_f32 v91, v91
  v_rcp_f32 v92, v92
  v_rcp_f32 v93, v93
  v_mfma_f32_32x32x16_bf16 v[112:127], v[252:255], a[60:63], v[112:127]
  v_cvt_pk_bf16_f32 v49, v90, v91
  ds_read_b128 a[20:23], v13 offset:16384
  v_cvt_pk_bf16_f32 v50, v92, v93
  v_rcp_f32 v94, v94
  v_mfma_f32_32x32x16_bf16 v[112:127], v[60:63], a[198:201], v[112:127]
  v_rcp_f32 v95, v95
  ds_read_b128 a[24:27], v14 offset:16384
  v_xad_u32 v1, v54, 32, v1
  buffer_load_dwordx4 v1, s[36:39], s53 offen offset:1024 nt lds
  v_mfma_f32_32x32x16_bf16 v[64:79], v[128:131], a[0:3], 0
  v_cvt_pk_bf16_f32 v51, v94, v95
  v_exp_f32 v96, v96
  v_exp_f32 v97, v97
  v_exp_f32 v98, v98
  v_mfma_f32_16x16x32_bf16 v[32:35], v[48:51], a[140:143], v[32:35]
  ds_read_b128 a[28:31], v15 offset:16384
  v_exp_f32 v99, v99
  s_waitcnt lgkmcnt(6)
  v_mfma_f32_32x32x16_bf16 v[64:79], v[132:135], a[4:7], v[64:79]
  v_exp_f32 v100, v100
  v_exp_f32 v101, v101
  v_exp_f32 v102, v102
  s_waitcnt lgkmcnt(5)
  v_mfma_f32_32x32x16_bf16 v[64:79], v[136:139], a[8:11], v[64:79]
  v_exp_f32 v103, v103
  ds_read_b128 v[36:39], v52 offset:4224
  v_exp_f32 v104, v104
  v_exp_f32 v105, v105
  s_waitcnt lgkmcnt(5)
  v_mfma_f32_32x32x16_bf16 v[64:79], v[140:143], a[12:15], v[64:79]
  v_exp_f32 v106, v106
  v_exp_f32 v107, v107
  v_exp_f32 v108, v108
  s_waitcnt lgkmcnt(4)
  v_mfma_f32_32x32x16_bf16 v[64:79], v[144:147], a[16:19], v[64:79]
  v_exp_f32 v109, v109
  v_exp_f32 v110, v110
  v_exp_f32 v111, v111
  s_waitcnt lgkmcnt(3)
  v_mfma_f32_32x32x16_bf16 v[64:79], v[148:151], a[20:23], v[64:79]
  ds_read_b64_tr_b16 a[64:65], v16 offset:16384
  v_xad_u32 v2, v54, 64, v2
  buffer_load_dwordx4 v2, s[36:39], s54 offen offset:2048 nt lds
  v_mfma_f32_32x32x16_bf16 v[96:111], a[192:195], a[196:199], v[96:111]
  ds_read_b64_tr_b16 a[66:67], v16 offset:16896
  ds_read_b64_tr_b16 a[68:69], v17 offset:16384
  ds_read_b64_tr_b16 a[70:71], v17 offset:16896
  v_xad_u32 v3, v54, s55, v3
  s_waitcnt lgkmcnt(6)
  v_mfma_f32_32x32x16_bf16 v[64:79], v[152:155], a[24:27], v[64:79]
  ds_read_b64_tr_b16 a[72:73], v18 offset:16384
  ds_read_b64_tr_b16 a[74:75], v18 offset:16896
  v_exp_f32 v112, v112
  v_exp_f32 v113, v113
  s_waitcnt lgkmcnt(7)
  v_mfma_f32_32x32x16_bf16 v[64:79], v[156:159], a[28:31], v[64:79]
  buffer_load_dwordx4 v3, s[36:39], 0 offen offset:3072 nt lds
  v_exp_f32 v114, v114
  v_rcp_f32 v96, v96
  v_mfma_f32_32x32x16_bf16 v[64:79], v[60:63], a[196:199], v[64:79]
  v_rcp_f32 v97, v97
  v_rcp_f32 v98, v98
  v_rcp_f32 v99, v99
  v_mfma_f32_32x32x16_bf16 v[80:95], v[160:163], a[0:3], 0
  v_cvt_pk_bf16_f32 v44, v96, v97
  v_rcp_f32 v100, v100
  v_cvt_pk_bf16_f32 v45, v98, v99
  v_rcp_f32 v101, v101
  v_mfma_f32_32x32x16_bf16 v[80:95], v[164:167], a[4:7], v[80:95]
  v_rcp_f32 v102, v102
  v_cvt_pk_bf16_f32 v46, v100, v101
  v_rcp_f32 v103, v103
  v_rcp_f32 v104, v104
  v_mfma_f32_32x32x16_bf16 v[80:95], v[168:171], a[8:11], v[80:95]
  v_cvt_pk_bf16_f32 v47, v102, v103
  v_rcp_f32 v105, v105
  v_rcp_f32 v106, v106
  v_rcp_f32 v107, v107
  v_mfma_f32_16x16x32_bf16 v[32:35], v[44:47], a[144:147], v[32:35]
  v_cvt_pk_bf16_f32 v48, v104, v105
  v_rcp_f32 v108, v108
  v_mfma_f32_32x32x16_bf16 v[80:95], v[172:175], a[12:15], v[80:95]
  v_cvt_pk_bf16_f32 v49, v106, v107
  v_rcp_f32 v109, v109
  v_rcp_f32 v110, v110
  v_rcp_f32 v111, v111
  v_mfma_f32_32x32x16_bf16 v[80:95], v[176:179], a[16:19], v[80:95]
  v_cvt_pk_bf16_f32 v50, v108, v109
  v_exp_f32 v115, v115
  v_cvt_pk_bf16_f32 v51, v110, v111
  v_exp_f32 v116, v116
  v_mfma_f32_32x32x16_bf16 v[80:95], v[180:183], a[20:23], v[80:95]
  v_exp_f32 v117, v117
  v_exp_f32 v118, v118
  v_exp_f32 v119, v119
  v_mfma_f32_16x16x32_bf16 v[32:35], v[48:51], a[148:151], v[32:35]
  v_exp_f32 v120, v120
  v_mfma_f32_32x32x16_bf16 v[80:95], v[184:187], a[24:27], v[80:95]
  v_exp_f32 v121, v121
  v_exp_f32 v122, v122
  v_exp_f32 v123, v123
  v_mfma_f32_32x32x16_bf16 v[80:95], v[188:191], a[28:31], v[80:95]
  v_exp_f32 v124, v124
  v_exp_f32 v125, v125
  v_exp_f32 v126, v126
  v_mfma_f32_32x32x16_bf16 v[80:95], v[60:63], a[200:203], v[80:95]
  v_exp_f32 v127, v127
  ds_read_b64_tr_b16 a[76:77], v19 offset:16384
  ds_read_b128 v[4:7], v53 offset:528
  s_add_u32 m0, s14, 4096
  v_mfma_f32_32x32x16_bf16 v[96:111], v[192:195], a[0:3], 0
  ds_read_b64_tr_b16 a[78:79], v19 offset:16896
  ds_read_b64_tr_b16 a[80:81], v20 offset:16384
  ds_read_b64_tr_b16 a[82:83], v20 offset:16896
  ds_read_b64_tr_b16 a[84:85], v21 offset:16384
  v_mfma_f32_32x32x16_bf16 v[112:127], a[192:195], a[196:199], v[112:127]
  v_exp_f32 v64, v64
  v_exp_f32 v65, v65
  v_exp_f32 v66, v66
  v_mfma_f32_32x32x16_bf16 v[96:111], v[196:199], a[4:7], v[96:111]
  v_exp_f32 v67, v67
  v_exp_f32 v68, v68
  v_exp_f32 v69, v69
  v_mfma_f32_32x32x16_bf16 v[96:111], v[200:203], a[8:11], v[96:111]
  v_exp_f32 v70, v70
  v_exp_f32 v71, v71
  v_exp_f32 v72, v72
  v_mfma_f32_32x32x16_bf16 v[96:111], v[204:207], a[12:15], v[96:111]
  v_rcp_f32 v112, v112
  v_rcp_f32 v113, v113
  v_rcp_f32 v114, v114
  v_mfma_f32_32x32x16_bf16 v[96:111], v[208:211], a[16:19], v[96:111]
  v_cvt_pk_bf16_f32 v44, v112, v113
  v_rcp_f32 v115, v115
  v_rcp_f32 v116, v116
  v_rcp_f32 v117, v117
  v_mfma_f32_32x32x16_bf16 v[96:111], v[212:215], a[20:23], v[96:111]
  v_cvt_pk_bf16_f32 v45, v114, v115
  v_rcp_f32 v118, v118
  v_cvt_pk_bf16_f32 v46, v116, v117
  v_rcp_f32 v119, v119
  v_mfma_f32_32x32x16_bf16 v[96:111], v[216:219], a[24:27], v[96:111]
  v_rcp_f32 v120, v120
  v_cvt_pk_bf16_f32 v47, v118, v119
  s_waitcnt lgkmcnt(4)
  v_xad_u32 v4, v54, s72, v4
  buffer_load_dwordx4 v4, s[36:39], s52 offen offset:0 nt lds
  v_mfma_f32_16x16x32_bf16 v[32:35], v[44:47], a[152:155], v[32:35]
  v_rcp_f32 v121, v121
  v_mfma_f32_32x32x16_bf16 v[96:111], v[220:223], a[28:31], v[96:111]
  v_rcp_f32 v122, v122
  v_cvt_pk_bf16_f32 v48, v120, v121
  v_rcp_f32 v123, v123
  v_rcp_f32 v124, v124
  v_mfma_f32_32x32x16_bf16 v[96:111], v[60:63], a[194:197], v[96:111]
  v_cvt_pk_bf16_f32 v49, v122, v123
  v_rcp_f32 v125, v125
  v_rcp_f32 v126, v126
  v_rcp_f32 v127, v127
  v_cvt_pk_bf16_f32 v50, v124, v125
  v_xad_u32 v5, v54, s73, v5
  buffer_load_dwordx4 v5, s[36:39], s53 offen offset:1024 nt lds
  v_cvt_pk_bf16_f32 v51, v126, v127
  v_mfma_f32_32x32x16_bf16 v[112:127], v[224:227], a[0:3], 0
  v_exp_f32 v73, v73
  v_exp_f32 v74, v74
  v_exp_f32 v75, v75
  v_mfma_f32_16x16x32_bf16 v[32:35], v[48:51], a[156:159], v[32:35]
  v_exp_f32 v76, v76
  v_mfma_f32_32x32x16_bf16 v[112:127], v[228:231], a[4:7], v[112:127]
  v_exp_f32 v77, v77
  v_exp_f32 v78, v78
  v_exp_f32 v79, v79
  v_mfma_f32_32x32x16_bf16 v[112:127], v[232:235], a[8:11], v[112:127]
  ds_read_b64_tr_b16 a[86:87], v21 offset:16896
  v_xad_u32 v6, v54, s74, v6
  v_mul_legacy_f32 v32, v32, v36
  v_mul_legacy_f32 v33, v33, v37
  v_mul_legacy_f32 v34, v34, v38
  v_mfma_f32_32x32x16_bf16 v[64:79], a[192:195], a[196:199], v[64:79]
  v_mul_legacy_f32 v35, v35, v39
  v_cvt_pk_bf16_f32 v40, v32, v33
  v_cvt_pk_bf16_f32 v41, v34, v35
  buffer_load_dwordx4 v6, s[36:39], s54 offen offset:2048 nt lds
  v_mfma_f32_32x32x16_bf16 v[112:127], v[236:239], a[12:15], v[112:127]
  v_mov_b32_dpp v42, v40 quad_perm:[1,0,3,2] row_mask:0xf bank_mask:0xf
  v_mov_b32_dpp v43, v41 quad_perm:[1,0,3,2] row_mask:0xf bank_mask:0xf
  ds_read_b64_tr_b16 a[88:89], v22 offset:16384
  ds_read_b64_tr_b16 a[90:91], v22 offset:16896
  v_mfma_f32_16x16x32_bf16 a[160:163], v[40:43], a[96:99], a[160:163]
  ds_read_b64_tr_b16 a[92:93], v23 offset:16384
  v_xad_u32 v7, v54, s11, v7
  v_mfma_f32_16x16x32_bf16 a[176:179], v[40:43], a[112:115], a[176:179]
  v_rcp_f32 v64, v64
  v_mfma_f32_16x16x32_bf16 a[164:167], v[40:43], a[100:103], a[164:167]
  v_rcp_f32 v65, v65
  v_mfma_f32_16x16x32_bf16 a[180:183], v[40:43], a[116:119], a[180:183]
  v_rcp_f32 v66, v66
  v_mfma_f32_16x16x32_bf16 a[168:171], v[40:43], a[104:107], a[168:171]
  v_cvt_pk_bf16_f32 v44, v64, v65
  v_rcp_f32 v67, v67
  v_mfma_f32_16x16x32_bf16 a[184:187], v[40:43], a[120:123], a[184:187]
  v_rcp_f32 v68, v68
  v_mfma_f32_16x16x32_bf16 a[172:175], v[40:43], a[108:111], a[172:175]
  v_cvt_pk_bf16_f32 v45, v66, v67
  v_rcp_f32 v69, v69
  v_mfma_f32_16x16x32_bf16 a[188:191], v[40:43], a[124:127], a[188:191]
  v_rcp_f32 v70, v70
  v_mfma_f32_32x32x16_bf16 v[112:127], v[240:243], a[16:19], v[112:127]
  v_cvt_pk_bf16_f32 v46, v68, v69
  v_rcp_f32 v71, v71
  v_rcp_f32 v72, v72
  buffer_load_dwordx4 v7, s[36:39], 0 offen offset:3072 nt lds
  v_mfma_f32_32x32x16_bf16 v[112:127], v[244:247], a[20:23], v[112:127]
  v_cvt_pk_bf16_f32 v47, v70, v71
  v_rcp_f32 v73, v73
  ds_read_b64_tr_b16 a[94:95], v23 offset:16896
  v_rcp_f32 v74, v74
  v_mfma_f32_16x16x32_bf16 v[32:35], v[44:47], a[128:131], v[28:31]
  v_cvt_pk_bf16_f32 v48, v72, v73
  v_rcp_f32 v75, v75
  v_mfma_f32_32x32x16_bf16 v[112:127], v[248:251], a[24:27], v[112:127]
  v_rcp_f32 v76, v76
  v_cvt_pk_bf16_f32 v49, v74, v75
  v_rcp_f32 v77, v77
  v_rcp_f32 v78, v78
  v_mfma_f32_32x32x16_bf16 v[112:127], v[252:255], a[28:31], v[112:127]
  v_cvt_pk_bf16_f32 v50, v76, v77
  v_rcp_f32 v79, v79
  v_exp_f32 v80, v80
  v_exp_f32 v81, v81
  v_mfma_f32_32x32x16_bf16 v[112:127], v[60:63], a[198:201], v[112:127]
  v_cvt_pk_bf16_f32 v51, v78, v79
  v_exp_f32 v82, v82
  v_exp_f32 v83, v83
  v_exp_f32 v84, v84
  v_mfma_f32_16x16x32_bf16 v[32:35], v[48:51], a[132:135], v[32:35]
  v_exp_f32 v85, v85
  v_exp_f32 v86, v86
  v_exp_f32 v87, v87
  v_exp_f32 v88, v88
  v_exp_f32 v89, v89
  v_exp_f32 v90, v90
  v_exp_f32 v91, v91
  v_exp_f32 v92, v92
  v_exp_f32 v93, v93
  v_exp_f32 v94, v94
  v_exp_f32 v95, v95
  s_waitcnt vmcnt(8)
  ds_read_b128 a[32:35], v8 offset:24576
  s_add_u32 m0, s14, 8192
  v_exp_f32 v96, v96
  v_mfma_f32_32x32x16_bf16 v[80:95], a[192:195], a[196:199], v[80:95]
  ds_read_b128 v[0:3], v53 offset:640
  v_exp_f32 v97, v97
  ds_read_b128 a[36:39], v9 offset:24576
  v_exp_f32 v98, v98
  ds_read_b128 a[40:43], v10 offset:24576
  v_exp_f32 v99, v99
  ds_read_b128 a[44:47], v11 offset:24576
  v_exp_f32 v100, v100
  ds_read_b128 a[48:51], v12 offset:24576
  v_exp_f32 v101, v101
  ds_read_b128 a[52:55], v13 offset:24576
  v_exp_f32 v102, v102
  v_rcp_f32 v80, v80
  v_rcp_f32 v81, v81
  v_rcp_f32 v82, v82
  v_rcp_f32 v83, v83
  v_cvt_pk_bf16_f32 v44, v80, v81
  v_rcp_f32 v84, v84
  s_waitcnt lgkmcnt(6)
  v_mfma_f32_32x32x16_bf16 v[64:79], v[128:131], a[32:35], 0
  v_cvt_pk_bf16_f32 v45, v82, v83
  v_rcp_f32 v85, v85
  v_rcp_f32 v86, v86
  v_rcp_f32 v87, v87
  v_cvt_pk_bf16_f32 v46, v84, v85
  s_waitcnt lgkmcnt(4)
  v_mfma_f32_32x32x16_bf16 v[64:79], v[132:135], a[36:39], v[64:79]
  v_rcp_f32 v88, v88
  v_cvt_pk_bf16_f32 v47, v86, v87
  v_xad_u32 v0, v54, 0, v0
  buffer_load_dwordx4 v0, s[36:39], s52 offen offset:0 nt lds
  v_mfma_f32_16x16x32_bf16 v[32:35], v[44:47], a[136:139], v[32:35]
  v_rcp_f32 v89, v89
  s_waitcnt lgkmcnt(3)
  v_mfma_f32_32x32x16_bf16 v[64:79], v[136:139], a[40:43], v[64:79]
  v_rcp_f32 v90, v90
  v_cvt_pk_bf16_f32 v48, v88, v89
  v_rcp_f32 v91, v91
  v_rcp_f32 v92, v92
  s_waitcnt lgkmcnt(2)
  v_mfma_f32_32x32x16_bf16 v[64:79], v[140:143], a[44:47], v[64:79]
  v_cvt_pk_bf16_f32 v49, v90, v91
  v_rcp_f32 v93, v93
  v_rcp_f32 v94, v94
  v_rcp_f32 v95, v95
  s_waitcnt lgkmcnt(1)
  v_mfma_f32_32x32x16_bf16 v[64:79], v[144:147], a[48:51], v[64:79]
  v_cvt_pk_bf16_f32 v50, v92, v93
  ds_read_b128 a[56:59], v14 offset:24576
  v_cvt_pk_bf16_f32 v51, v94, v95
  v_xad_u32 v1, v54, 32, v1
  buffer_load_dwordx4 v1, s[36:39], s53 offen offset:1024 nt lds
  v_mfma_f32_16x16x32_bf16 v[32:35], v[48:51], a[140:143], v[32:35]
  ds_read_b128 a[60:63], v15 offset:24576
  v_exp_f32 v103, v103
  s_waitcnt lgkmcnt(2)
  v_mfma_f32_32x32x16_bf16 v[64:79], v[148:151], a[52:55], v[64:79]
  ds_read_b128 v[36:39], v52 offset:4352
  v_exp_f32 v104, v104
  v_exp_f32 v105, v105
  v_exp_f32 v106, v106
  v_mfma_f32_32x32x16_bf16 v[80:95], v[160:163], a[32:35], 0
  v_exp_f32 v107, v107
  v_exp_f32 v108, v108
  v_exp_f32 v109, v109
  v_mfma_f32_32x32x16_bf16 v[80:95], v[164:167], a[36:39], v[80:95]
  v_exp_f32 v110, v110
  v_exp_f32 v111, v111
  ds_read_b64_tr_b16 a[96:97], v16 offset:24576
  v_xad_u32 v2, v54, 64, v2
  v_mfma_f32_32x32x16_bf16 v[80:95], v[168:171], a[40:43], v[80:95]
  buffer_load_dwordx4 v2, s[36:39], s54 offen offset:2048 nt lds
  ds_read_b64_tr_b16 a[98:99], v16 offset:25088
  ds_read_b64_tr_b16 a[100:101], v17 offset:24576
  v_mfma_f32_32x32x16_bf16 v[96:111], a[192:195], a[196:199], v[96:111]
  ds_read_b64_tr_b16 a[102:103], v17 offset:25088
  v_xad_u32 v3, v54, s55, v3
  ds_read_b64_tr_b16 a[104:105], v18 offset:24576
  ds_read_b64_tr_b16 a[106:107], v18 offset:25088
  s_waitcnt lgkmcnt(8)
  v_mfma_f32_32x32x16_bf16 v[64:79], v[152:155], a[56:59], v[64:79]
  v_exp_f32 v112, v112
  v_exp_f32 v113, v113
  buffer_load_dwordx4 v3, s[36:39], 0 offen offset:3072 nt lds
  s_waitcnt lgkmcnt(7)
  v_mfma_f32_32x32x16_bf16 v[64:79], v[156:159], a[60:63], v[64:79]
  v_exp_f32 v114, v114
  v_exp_f32 v115, v115
  v_exp_f32 v116, v116
  v_mfma_f32_32x32x16_bf16 v[64:79], v[60:63], a[196:199], v[64:79]
  v_rcp_f32 v96, v96
  v_rcp_f32 v97, v97
  v_rcp_f32 v98, v98
  v_mfma_f32_32x32x16_bf16 v[80:95], v[172:175], a[44:47], v[80:95]
  v_cvt_pk_bf16_f32 v44, v96, v97
  v_rcp_f32 v99, v99
  v_rcp_f32 v100, v100
  v_rcp_f32 v101, v101
  v_mfma_f32_32x32x16_bf16 v[80:95], v[176:179], a[48:51], v[80:95]
  v_cvt_pk_bf16_f32 v45, v98, v99
  v_rcp_f32 v102, v102
  v_cvt_pk_bf16_f32 v46, v100, v101
  v_rcp_f32 v103, v103
  v_mfma_f32_32x32x16_bf16 v[80:95], v[180:183], a[52:55], v[80:95]
  v_rcp_f32 v104, v104
  v_cvt_pk_bf16_f32 v47, v102, v103
  v_rcp_f32 v105, v105
  v_rcp_f32 v106, v106
  v_mfma_f32_16x16x32_bf16 v[32:35], v[44:47], a[144:147], v[32:35]
  v_cvt_pk_bf16_f32 v48, v104, v105
  v_rcp_f32 v107, v107
  v_mfma_f32_32x32x16_bf16 v[80:95], v[184:187], a[56:59], v[80:95]
  v_rcp_f32 v108, v108
  v_cvt_pk_bf16_f32 v49, v106, v107
  v_rcp_f32 v109, v109
  v_rcp_f32 v110, v110
  v_mfma_f32_32x32x16_bf16 v[80:95], v[188:191], a[60:63], v[80:95]
  v_cvt_pk_bf16_f32 v50, v108, v109
  v_rcp_f32 v111, v111
  v_exp_f32 v117, v117
  v_exp_f32 v118, v118
  v_mfma_f32_32x32x16_bf16 v[80:95], v[60:63], a[200:203], v[80:95]
  v_cvt_pk_bf16_f32 v51, v110, v111
  v_exp_f32 v119, v119
  v_exp_f32 v120, v120
  v_exp_f32 v121, v121
  v_mfma_f32_16x16x32_bf16 v[32:35], v[48:51], a[148:151], v[32:35]
  v_exp_f32 v122, v122
  v_mfma_f32_32x32x16_bf16 v[96:111], v[192:195], a[32:35], 0
  v_exp_f32 v123, v123
  v_exp_f32 v124, v124
  v_exp_f32 v125, v125
  v_mfma_f32_32x32x16_bf16 v[96:111], v[196:199], a[36:39], v[96:111]
  v_exp_f32 v126, v126
  v_exp_f32 v127, v127
  ds_read_b64_tr_b16 a[108:109], v19 offset:24576
  ds_read_b128 v[4:7], v53 offset:656
  v_mfma_f32_32x32x16_bf16 v[96:111], v[200:203], a[40:43], v[96:111]
  ds_read_b64_tr_b16 a[110:111], v19 offset:25088
  ds_read_b64_tr_b16 a[112:113], v20 offset:24576
  ds_read_b64_tr_b16 a[114:115], v20 offset:25088
  s_add_u32 m0, s14, 12288
  v_mfma_f32_32x32x16_bf16 v[112:127], a[192:195], a[196:199], v[112:127]
  ds_read_b64_tr_b16 a[116:117], v21 offset:24576
  v_exp_f32 v64, v64
  v_exp_f32 v65, v65
  v_exp_f32 v66, v66
  v_mfma_f32_32x32x16_bf16 v[96:111], v[204:207], a[44:47], v[96:111]
  v_exp_f32 v67, v67
  v_exp_f32 v68, v68
  v_exp_f32 v69, v69
  v_mfma_f32_32x32x16_bf16 v[96:111], v[208:211], a[48:51], v[96:111]
  v_exp_f32 v70, v70
  v_exp_f32 v71, v71
  v_exp_f32 v72, v72
  v_mfma_f32_32x32x16_bf16 v[96:111], v[212:215], a[52:55], v[96:111]
  v_rcp_f32 v112, v112
  v_rcp_f32 v113, v113
  v_rcp_f32 v114, v114
  v_mfma_f32_32x32x16_bf16 v[96:111], v[216:219], a[56:59], v[96:111]
  v_cvt_pk_bf16_f32 v44, v112, v113
  v_rcp_f32 v115, v115
  v_rcp_f32 v116, v116
  v_rcp_f32 v117, v117
  v_mfma_f32_32x32x16_bf16 v[96:111], v[220:223], a[60:63], v[96:111]
  v_cvt_pk_bf16_f32 v45, v114, v115
  v_rcp_f32 v118, v118
  v_cvt_pk_bf16_f32 v46, v116, v117
  v_rcp_f32 v119, v119
  v_mfma_f32_32x32x16_bf16 v[96:111], v[60:63], a[194:197], v[96:111]
  v_rcp_f32 v120, v120
  v_cvt_pk_bf16_f32 v47, v118, v119
  s_waitcnt lgkmcnt(4)
  v_xad_u32 v4, v54, s72, v4
  buffer_load_dwordx4 v4, s[36:39], s52 offen offset:0 nt lds
  v_mfma_f32_16x16x32_bf16 v[32:35], v[44:47], a[152:155], v[32:35]
  v_rcp_f32 v121, v121
  v_rcp_f32 v122, v122
  v_rcp_f32 v123, v123
  v_cvt_pk_bf16_f32 v48, v120, v121
  v_rcp_f32 v124, v124
  v_rcp_f32 v125, v125
  v_cvt_pk_bf16_f32 v49, v122, v123
  v_rcp_f32 v126, v126
  v_rcp_f32 v127, v127
  v_cvt_pk_bf16_f32 v50, v124, v125
  v_xad_u32 v5, v54, s73, v5
  buffer_load_dwordx4 v5, s[36:39], s53 offen offset:1024 nt lds
  v_cvt_pk_bf16_f32 v51, v126, v127
  v_mfma_f32_32x32x16_bf16 v[112:127], v[224:227], a[32:35], 0
  v_exp_f32 v73, v73
  v_exp_f32 v74, v74
  v_exp_f32 v75, v75
  v_mfma_f32_16x16x32_bf16 v[32:35], v[48:51], a[156:159], v[32:35]
  v_exp_f32 v76, v76
  v_mfma_f32_32x32x16_bf16 v[112:127], v[228:231], a[36:39], v[112:127]
  v_exp_f32 v77, v77
  v_exp_f32 v78, v78
  v_exp_f32 v79, v79
  v_mfma_f32_32x32x16_bf16 v[112:127], v[232:235], a[40:43], v[112:127]
  ds_read_b64_tr_b16 a[118:119], v21 offset:25088
  v_xad_u32 v6, v54, s74, v6
  v_mul_legacy_f32 v32, v32, v36
  v_mul_legacy_f32 v33, v33, v37
  v_mul_legacy_f32 v34, v34, v38
  v_mfma_f32_32x32x16_bf16 v[64:79], a[192:195], a[196:199], v[64:79]
  v_mul_legacy_f32 v35, v35, v39
  v_cvt_pk_bf16_f32 v40, v32, v33
  v_cvt_pk_bf16_f32 v41, v34, v35
  buffer_load_dwordx4 v6, s[36:39], s54 offen offset:2048 nt lds
  v_mfma_f32_32x32x16_bf16 v[112:127], v[236:239], a[44:47], v[112:127]
  v_mov_b32_dpp v42, v40 quad_perm:[1,0,3,2] row_mask:0xf bank_mask:0xf
  v_mov_b32_dpp v43, v41 quad_perm:[1,0,3,2] row_mask:0xf bank_mask:0xf
  ds_read_b64_tr_b16 a[120:121], v22 offset:24576
  ds_read_b64_tr_b16 a[122:123], v22 offset:25088
  v_mfma_f32_16x16x32_bf16 a[160:163], v[40:43], a[64:67], a[160:163]
  ds_read_b64_tr_b16 a[124:125], v23 offset:24576
  v_xad_u32 v7, v54, s11, v7
  v_mfma_f32_16x16x32_bf16 a[176:179], v[40:43], a[80:83], a[176:179]
  v_rcp_f32 v64, v64
  v_mfma_f32_16x16x32_bf16 a[164:167], v[40:43], a[68:71], a[164:167]
  v_rcp_f32 v65, v65
  v_mfma_f32_16x16x32_bf16 a[180:183], v[40:43], a[84:87], a[180:183]
  v_rcp_f32 v66, v66
  v_mfma_f32_16x16x32_bf16 a[168:171], v[40:43], a[72:75], a[168:171]
  v_cvt_pk_bf16_f32 v44, v64, v65
  v_rcp_f32 v67, v67
  v_mfma_f32_16x16x32_bf16 a[184:187], v[40:43], a[88:91], a[184:187]
  v_rcp_f32 v68, v68
  v_mfma_f32_16x16x32_bf16 a[172:175], v[40:43], a[76:79], a[172:175]
  v_cvt_pk_bf16_f32 v45, v66, v67
  v_rcp_f32 v69, v69
  v_mfma_f32_16x16x32_bf16 a[188:191], v[40:43], a[92:95], a[188:191]
  v_rcp_f32 v70, v70
  v_mfma_f32_32x32x16_bf16 v[112:127], v[240:243], a[48:51], v[112:127]
  v_cvt_pk_bf16_f32 v46, v68, v69
  v_rcp_f32 v71, v71
  v_rcp_f32 v72, v72
  buffer_load_dwordx4 v7, s[36:39], 0 offen offset:3072 nt lds
  v_mfma_f32_32x32x16_bf16 v[112:127], v[244:247], a[52:55], v[112:127]
  v_cvt_pk_bf16_f32 v47, v70, v71
  v_rcp_f32 v73, v73
  ds_read_b64_tr_b16 a[126:127], v23 offset:25088
  v_rcp_f32 v74, v74
  v_mfma_f32_16x16x32_bf16 v[32:35], v[44:47], a[128:131], v[28:31]
  v_cvt_pk_bf16_f32 v48, v72, v73
  v_rcp_f32 v75, v75
  v_mfma_f32_32x32x16_bf16 v[112:127], v[248:251], a[56:59], v[112:127]
  v_rcp_f32 v76, v76
  v_cvt_pk_bf16_f32 v49, v74, v75
  v_rcp_f32 v77, v77
  v_rcp_f32 v78, v78
  v_mfma_f32_32x32x16_bf16 v[112:127], v[252:255], a[60:63], v[112:127]
  v_cvt_pk_bf16_f32 v50, v76, v77
  v_rcp_f32 v79, v79
  v_exp_f32 v80, v80
  v_exp_f32 v81, v81
  v_mfma_f32_32x32x16_bf16 v[112:127], v[60:63], a[198:201], v[112:127]
  v_cvt_pk_bf16_f32 v51, v78, v79
  v_exp_f32 v82, v82
  v_exp_f32 v83, v83
  v_exp_f32 v84, v84
  v_mfma_f32_16x16x32_bf16 v[32:35], v[48:51], a[132:135], v[32:35]
  v_exp_f32 v85, v85
  v_exp_f32 v86, v86
  v_exp_f32 v87, v87
  v_exp_f32 v88, v88
  v_exp_f32 v89, v89
  v_exp_f32 v90, v90
  v_exp_f32 v91, v91
  v_exp_f32 v92, v92
  v_exp_f32 v93, v93
  v_exp_f32 v94, v94
  v_exp_f32 v95, v95
  s_waitcnt vmcnt(8)
  ds_read_b128 a[0:3], v8 offset:0
  v_exp_f32 v96, v96
  ds_read_b128 a[4:7], v9 offset:0
  v_mfma_f32_32x32x16_bf16 v[80:95], a[192:195], a[196:199], v[80:95]
  ds_read_b128 a[8:11], v10 offset:0
  v_exp_f32 v97, v97
  ds_read_b128 a[12:15], v11 offset:0
  v_exp_f32 v98, v98
  ds_read_b128 a[16:19], v12 offset:0
  v_exp_f32 v99, v99
  ds_read_b128 a[20:23], v13 offset:0
  v_exp_f32 v100, v100
  ds_read_b128 a[24:27], v14 offset:0
  v_exp_f32 v101, v101
  ds_read_b128 a[28:31], v15 offset:0
  v_exp_f32 v102, v102
  v_rcp_f32 v80, v80
  v_rcp_f32 v81, v81
  v_rcp_f32 v82, v82
  v_rcp_f32 v83, v83
  v_cvt_pk_bf16_f32 v44, v80, v81
  v_rcp_f32 v84, v84
  s_waitcnt lgkmcnt(7)
  v_mfma_f32_32x32x16_bf16 v[64:79], v[128:131], a[0:3], 0
  v_cvt_pk_bf16_f32 v45, v82, v83
  v_rcp_f32 v85, v85
  v_rcp_f32 v86, v86
  v_rcp_f32 v87, v87
  s_waitcnt lgkmcnt(6)
  v_mfma_f32_32x32x16_bf16 v[64:79], v[132:135], a[4:7], v[64:79]
  v_cvt_pk_bf16_f32 v46, v84, v85
  v_rcp_f32 v88, v88
  v_cvt_pk_bf16_f32 v47, v86, v87
  v_rcp_f32 v89, v89
  s_waitcnt lgkmcnt(5)
  v_mfma_f32_32x32x16_bf16 v[64:79], v[136:139], a[8:11], v[64:79]
  v_rcp_f32 v90, v90
  v_cvt_pk_bf16_f32 v48, v88, v89
  v_rcp_f32 v91, v91
  v_rcp_f32 v92, v92
  v_mfma_f32_16x16x32_bf16 v[32:35], v[44:47], a[136:139], v[32:35]
  v_cvt_pk_bf16_f32 v49, v90, v91
  v_rcp_f32 v93, v93
  s_waitcnt lgkmcnt(4)
  v_mfma_f32_32x32x16_bf16 v[64:79], v[140:143], a[12:15], v[64:79]
  v_rcp_f32 v94, v94
  v_cvt_pk_bf16_f32 v50, v92, v93
  v_rcp_f32 v95, v95
  ds_read_b128 v[36:39], v52 offset:4480
  s_waitcnt lgkmcnt(4)
  v_mfma_f32_32x32x16_bf16 v[64:79], v[144:147], a[16:19], v[64:79]
  v_cvt_pk_bf16_f32 v51, v94, v95
  v_exp_f32 v103, v103
  v_exp_f32 v104, v104
  v_exp_f32 v105, v105
  v_mfma_f32_16x16x32_bf16 v[32:35], v[48:51], a[140:143], v[32:35]
  v_exp_f32 v106, v106
  s_waitcnt lgkmcnt(3)
  v_mfma_f32_32x32x16_bf16 v[64:79], v[148:151], a[20:23], v[64:79]
  v_exp_f32 v107, v107
  v_exp_f32 v108, v108
  v_exp_f32 v109, v109
  s_waitcnt lgkmcnt(2)
  v_mfma_f32_32x32x16_bf16 v[64:79], v[152:155], a[24:27], v[64:79]
  v_exp_f32 v110, v110
  v_exp_f32 v111, v111
  ds_read_b64_tr_b16 a[64:65], v16 offset:0
  ds_read_b64_tr_b16 a[66:67], v16 offset:512
  s_waitcnt lgkmcnt(3)
  v_mfma_f32_32x32x16_bf16 v[64:79], v[156:159], a[28:31], v[64:79]
  ds_read_b64_tr_b16 a[68:69], v17 offset:0
  ds_read_b64_tr_b16 a[70:71], v17 offset:512
  ds_read_b64_tr_b16 a[72:73], v18 offset:0
  ds_read_b64_tr_b16 a[74:75], v18 offset:512
  v_mfma_f32_32x32x16_bf16 v[96:111], a[192:195], a[196:199], v[96:111]
  v_exp_f32 v112, v112
  v_exp_f32 v113, v113
  v_exp_f32 v114, v114
  v_mfma_f32_32x32x16_bf16 v[64:79], v[60:63], a[196:199], v[64:79]
  v_exp_f32 v115, v115
  v_exp_f32 v116, v116
  v_exp_f32 v117, v117
  v_mfma_f32_32x32x16_bf16 v[80:95], v[160:163], a[0:3], 0
  v_exp_f32 v118, v118
  v_exp_f32 v119, v119
  v_exp_f32 v120, v120
  v_mfma_f32_32x32x16_bf16 v[80:95], v[164:167], a[4:7], v[80:95]
  v_rcp_f32 v96, v96
  v_rcp_f32 v97, v97
  v_rcp_f32 v98, v98
  v_mfma_f32_32x32x16_bf16 v[80:95], v[168:171], a[8:11], v[80:95]
  v_cvt_pk_bf16_f32 v44, v96, v97
  v_rcp_f32 v99, v99
  v_rcp_f32 v100, v100
  v_rcp_f32 v101, v101
  v_mfma_f32_32x32x16_bf16 v[80:95], v[172:175], a[12:15], v[80:95]
  v_cvt_pk_bf16_f32 v45, v98, v99
  v_rcp_f32 v102, v102
  v_cvt_pk_bf16_f32 v46, v100, v101
  v_rcp_f32 v103, v103
  v_mfma_f32_32x32x16_bf16 v[80:95], v[176:179], a[16:19], v[80:95]
  v_rcp_f32 v104, v104
  v_cvt_pk_bf16_f32 v47, v102, v103
  v_rcp_f32 v105, v105
  v_rcp_f32 v106, v106
  v_mfma_f32_16x16x32_bf16 v[32:35], v[44:47], a[144:147], v[32:35]
  v_cvt_pk_bf16_f32 v48, v104, v105
  v_rcp_f32 v107, v107
  v_mfma_f32_32x32x16_bf16 v[80:95], v[180:183], a[20:23], v[80:95]
  v_rcp_f32 v108, v108
  v_cvt_pk_bf16_f32 v49, v106, v107
  v_rcp_f32 v109, v109
  v_rcp_f32 v110, v110
  v_mfma_f32_32x32x16_bf16 v[80:95], v[184:187], a[24:27], v[80:95]
  v_cvt_pk_bf16_f32 v50, v108, v109
  v_rcp_f32 v111, v111
  v_exp_f32 v121, v121
  v_exp_f32 v122, v122
  v_mfma_f32_32x32x16_bf16 v[80:95], v[188:191], a[28:31], v[80:95]
  v_cvt_pk_bf16_f32 v51, v110, v111
  v_exp_f32 v123, v123
  v_exp_f32 v124, v124
  v_exp_f32 v125, v125
  v_mfma_f32_16x16x32_bf16 v[32:35], v[48:51], a[148:151], v[32:35]
  v_exp_f32 v126, v126
  v_mfma_f32_32x32x16_bf16 v[80:95], v[60:63], a[200:203], v[80:95]
  v_exp_f32 v127, v127
  ds_read_b64_tr_b16 a[76:77], v19 offset:0
  ds_read_b64_tr_b16 a[78:79], v19 offset:512
  ds_read_b64_tr_b16 a[80:81], v20 offset:0
  v_mfma_f32_32x32x16_bf16 v[112:127], a[192:195], a[196:199], v[112:127]
  ds_read_b64_tr_b16 a[82:83], v20 offset:512
  ds_read_b64_tr_b16 a[84:85], v21 offset:0
  v_exp_f32 v64, v64
  v_exp_f32 v65, v65
  v_mfma_f32_32x32x16_bf16 v[96:111], v[192:195], a[0:3], 0
  v_exp_f32 v66, v66
  v_exp_f32 v67, v67
  v_exp_f32 v68, v68
  v_mfma_f32_32x32x16_bf16 v[96:111], v[196:199], a[4:7], v[96:111]
  v_exp_f32 v69, v69
  v_exp_f32 v70, v70
  v_exp_f32 v71, v71
  v_mfma_f32_32x32x16_bf16 v[96:111], v[200:203], a[8:11], v[96:111]
  v_rcp_f32 v112, v112
  v_rcp_f32 v113, v113
  v_rcp_f32 v114, v114
  v_mfma_f32_32x32x16_bf16 v[96:111], v[204:207], a[12:15], v[96:111]
  v_cvt_pk_bf16_f32 v44, v112, v113
  v_rcp_f32 v115, v115
  v_rcp_f32 v116, v116
  v_rcp_f32 v117, v117
  v_mfma_f32_32x32x16_bf16 v[96:111], v[208:211], a[16:19], v[96:111]
  v_cvt_pk_bf16_f32 v45, v114, v115
  v_rcp_f32 v118, v118
  v_cvt_pk_bf16_f32 v46, v116, v117
  v_rcp_f32 v119, v119
  v_mfma_f32_32x32x16_bf16 v[96:111], v[212:215], a[20:23], v[96:111]
  v_rcp_f32 v120, v120
  v_cvt_pk_bf16_f32 v47, v118, v119
  v_rcp_f32 v121, v121
  v_rcp_f32 v122, v122
  v_mfma_f32_16x16x32_bf16 v[32:35], v[44:47], a[152:155], v[32:35]
  v_cvt_pk_bf16_f32 v48, v120, v121
  v_rcp_f32 v123, v123
  v_mfma_f32_32x32x16_bf16 v[96:111], v[216:219], a[24:27], v[96:111]
  v_rcp_f32 v124, v124
  v_cvt_pk_bf16_f32 v49, v122, v123
  v_rcp_f32 v125, v125
  v_rcp_f32 v126, v126
  v_mfma_f32_32x32x16_bf16 v[96:111], v[220:223], a[28:31], v[96:111]
  v_cvt_pk_bf16_f32 v50, v124, v125
  v_rcp_f32 v127, v127
  v_exp_f32 v72, v72
  v_exp_f32 v73, v73
  v_mfma_f32_32x32x16_bf16 v[96:111], v[60:63], a[194:197], v[96:111]
  v_cvt_pk_bf16_f32 v51, v126, v127
  v_exp_f32 v74, v74
  v_exp_f32 v75, v75
  v_exp_f32 v76, v76
  v_mfma_f32_16x16x32_bf16 v[32:35], v[48:51], a[156:159], v[32:35]
  v_exp_f32 v77, v77
  v_mfma_f32_32x32x16_bf16 v[112:127], v[224:227], a[0:3], 0
  v_exp_f32 v78, v78
  v_exp_f32 v79, v79
  ds_read_b64_tr_b16 a[86:87], v21 offset:512
  ds_read_b64_tr_b16 a[88:89], v22 offset:0
  v_mfma_f32_32x32x16_bf16 v[112:127], v[228:231], a[4:7], v[112:127]
  ds_read_b64_tr_b16 a[90:91], v22 offset:512
  s_waitcnt lgkmcnt(14)
  v_mul_legacy_f32 v32, v32, v36
  v_mul_legacy_f32 v33, v33, v37
  v_mul_legacy_f32 v34, v34, v38
  v_mul_legacy_f32 v35, v35, v39
  v_cvt_pk_bf16_f32 v40, v32, v33
  v_mfma_f32_32x32x16_bf16 v[64:79], a[192:195], a[196:199], v[64:79]
  v_cvt_pk_bf16_f32 v41, v34, v35
  v_mov_b32_dpp v42, v40 quad_perm:[1,0,3,2] row_mask:0xf bank_mask:0xf
  ds_read_b64_tr_b16 a[92:93], v23 offset:0
  v_mov_b32_dpp v43, v41 quad_perm:[1,0,3,2] row_mask:0xf bank_mask:0xf
  ds_read_b64_tr_b16 a[94:95], v23 offset:512
  v_mfma_f32_32x32x16_bf16 v[112:127], v[232:235], a[8:11], v[112:127]
  v_exp_f32 v80, v80
  v_exp_f32 v81, v81
  v_exp_f32 v82, v82
  v_mfma_f32_16x16x32_bf16 a[160:163], v[40:43], a[96:99], a[160:163]
  v_exp_f32 v83, v83
  v_mfma_f32_16x16x32_bf16 a[176:179], v[40:43], a[112:115], a[176:179]
  v_rcp_f32 v64, v64
  v_mfma_f32_16x16x32_bf16 a[164:167], v[40:43], a[100:103], a[164:167]
  v_rcp_f32 v65, v65
  v_mfma_f32_16x16x32_bf16 a[180:183], v[40:43], a[116:119], a[180:183]
  v_rcp_f32 v66, v66
  v_mfma_f32_16x16x32_bf16 a[168:171], v[40:43], a[104:107], a[168:171]
  v_cvt_pk_bf16_f32 v44, v64, v65
  v_rcp_f32 v67, v67
  v_mfma_f32_16x16x32_bf16 a[184:187], v[40:43], a[120:123], a[184:187]
  v_rcp_f32 v68, v68
  v_mfma_f32_16x16x32_bf16 a[172:175], v[40:43], a[108:111], a[172:175]
  v_cvt_pk_bf16_f32 v45, v66, v67
  v_rcp_f32 v69, v69
  v_mfma_f32_16x16x32_bf16 a[188:191], v[40:43], a[124:127], a[188:191]
  v_rcp_f32 v70, v70
  v_mfma_f32_32x32x16_bf16 v[112:127], v[236:239], a[12:15], v[112:127]
  v_cvt_pk_bf16_f32 v46, v68, v69
  v_rcp_f32 v71, v71
  v_rcp_f32 v72, v72
  v_rcp_f32 v73, v73
  v_mfma_f32_32x32x16_bf16 v[112:127], v[240:243], a[16:19], v[112:127]
  v_cvt_pk_bf16_f32 v47, v70, v71
  v_rcp_f32 v74, v74
  v_cvt_pk_bf16_f32 v48, v72, v73
  v_rcp_f32 v75, v75
  v_mfma_f32_16x16x32_bf16 v[32:35], v[44:47], a[128:131], v[28:31]
  v_rcp_f32 v76, v76
  v_mfma_f32_32x32x16_bf16 v[112:127], v[244:247], a[20:23], v[112:127]
  v_cvt_pk_bf16_f32 v49, v74, v75
  v_rcp_f32 v77, v77
  v_rcp_f32 v78, v78
  v_rcp_f32 v79, v79
  v_mfma_f32_32x32x16_bf16 v[112:127], v[248:251], a[24:27], v[112:127]
  v_cvt_pk_bf16_f32 v50, v76, v77
  v_exp_f32 v84, v84
  v_cvt_pk_bf16_f32 v51, v78, v79
  v_exp_f32 v85, v85
  v_mfma_f32_32x32x16_bf16 v[112:127], v[252:255], a[28:31], v[112:127]
  v_exp_f32 v86, v86
  v_exp_f32 v87, v87
  v_exp_f32 v88, v88
  v_mfma_f32_16x16x32_bf16 v[32:35], v[48:51], a[132:135], v[32:35]
  v_exp_f32 v89, v89
  v_mfma_f32_32x32x16_bf16 v[112:127], v[60:63], a[198:201], v[112:127]
  v_exp_f32 v90, v90
  v_exp_f32 v91, v91
  v_exp_f32 v92, v92
  v_exp_f32 v93, v93
  v_exp_f32 v94, v94
  v_exp_f32 v95, v95
  s_waitcnt vmcnt(0)
  ds_read_b128 a[32:35], v8 offset:8192
  v_exp_f32 v96, v96
  ds_read_b128 a[36:39], v9 offset:8192
  v_mfma_f32_32x32x16_bf16 v[80:95], a[192:195], a[196:199], v[80:95]
  ds_read_b128 a[40:43], v10 offset:8192
  v_exp_f32 v97, v97
  ds_read_b128 a[44:47], v11 offset:8192
  v_exp_f32 v98, v98
  ds_read_b128 a[48:51], v12 offset:8192
  v_exp_f32 v99, v99
  ds_read_b128 a[52:55], v13 offset:8192
  v_exp_f32 v100, v100
  ds_read_b128 a[56:59], v14 offset:8192
  v_exp_f32 v101, v101
  ds_read_b128 a[60:63], v15 offset:8192
  v_exp_f32 v102, v102
  v_rcp_f32 v80, v80
  v_rcp_f32 v81, v81
  v_rcp_f32 v82, v82
  v_rcp_f32 v83, v83
  v_cvt_pk_bf16_f32 v44, v80, v81
  v_rcp_f32 v84, v84
  s_waitcnt lgkmcnt(7)
  v_mfma_f32_32x32x16_bf16 v[64:79], v[128:131], a[32:35], 0
  v_cvt_pk_bf16_f32 v45, v82, v83
  v_rcp_f32 v85, v85
  v_rcp_f32 v86, v86
  v_rcp_f32 v87, v87
  s_waitcnt lgkmcnt(6)
  v_mfma_f32_32x32x16_bf16 v[64:79], v[132:135], a[36:39], v[64:79]
  v_cvt_pk_bf16_f32 v46, v84, v85
  v_rcp_f32 v88, v88
  v_cvt_pk_bf16_f32 v47, v86, v87
  v_rcp_f32 v89, v89
  s_waitcnt lgkmcnt(5)
  v_mfma_f32_32x32x16_bf16 v[64:79], v[136:139], a[40:43], v[64:79]
  v_rcp_f32 v90, v90
  v_cvt_pk_bf16_f32 v48, v88, v89
  v_rcp_f32 v91, v91
  v_rcp_f32 v92, v92
  v_mfma_f32_16x16x32_bf16 v[32:35], v[44:47], a[136:139], v[32:35]
  v_cvt_pk_bf16_f32 v49, v90, v91
  v_rcp_f32 v93, v93
  s_waitcnt lgkmcnt(4)
  v_mfma_f32_32x32x16_bf16 v[64:79], v[140:143], a[44:47], v[64:79]
  v_rcp_f32 v94, v94
  v_cvt_pk_bf16_f32 v50, v92, v93
  v_rcp_f32 v95, v95
  ds_read_b128 v[36:39], v52 offset:4608
  s_waitcnt lgkmcnt(4)
  v_mfma_f32_32x32x16_bf16 v[64:79], v[144:147], a[48:51], v[64:79]
  v_cvt_pk_bf16_f32 v51, v94, v95
  v_exp_f32 v103, v103
  v_exp_f32 v104, v104
  v_exp_f32 v105, v105
  v_mfma_f32_16x16x32_bf16 v[32:35], v[48:51], a[140:143], v[32:35]
  v_exp_f32 v106, v106
  s_waitcnt lgkmcnt(3)
  v_mfma_f32_32x32x16_bf16 v[64:79], v[148:151], a[52:55], v[64:79]
  v_exp_f32 v107, v107
  v_exp_f32 v108, v108
  v_exp_f32 v109, v109
  s_waitcnt lgkmcnt(2)
  v_mfma_f32_32x32x16_bf16 v[64:79], v[152:155], a[56:59], v[64:79]
  v_exp_f32 v110, v110
  v_exp_f32 v111, v111
  ds_read_b64_tr_b16 a[96:97], v16 offset:8192
  ds_read_b64_tr_b16 a[98:99], v16 offset:8704
  s_waitcnt lgkmcnt(3)
  v_mfma_f32_32x32x16_bf16 v[64:79], v[156:159], a[60:63], v[64:79]
  ds_read_b64_tr_b16 a[100:101], v17 offset:8192
  ds_read_b64_tr_b16 a[102:103], v17 offset:8704
  ds_read_b64_tr_b16 a[104:105], v18 offset:8192
  ds_read_b64_tr_b16 a[106:107], v18 offset:8704
  v_mfma_f32_32x32x16_bf16 v[96:111], a[192:195], a[196:199], v[96:111]
  v_exp_f32 v112, v112
  v_exp_f32 v113, v113
  v_exp_f32 v114, v114
  v_mfma_f32_32x32x16_bf16 v[64:79], v[60:63], a[196:199], v[64:79]
  v_exp_f32 v115, v115
  v_exp_f32 v116, v116
  v_exp_f32 v117, v117
  v_mfma_f32_32x32x16_bf16 v[80:95], v[160:163], a[32:35], 0
  v_exp_f32 v118, v118
  v_exp_f32 v119, v119
  v_exp_f32 v120, v120
  v_mfma_f32_32x32x16_bf16 v[80:95], v[164:167], a[36:39], v[80:95]
  v_rcp_f32 v96, v96
  v_rcp_f32 v97, v97
  v_rcp_f32 v98, v98
  v_mfma_f32_32x32x16_bf16 v[80:95], v[168:171], a[40:43], v[80:95]
  v_cvt_pk_bf16_f32 v44, v96, v97
  v_rcp_f32 v99, v99
  v_rcp_f32 v100, v100
  v_rcp_f32 v101, v101
  v_mfma_f32_32x32x16_bf16 v[80:95], v[172:175], a[44:47], v[80:95]
  v_cvt_pk_bf16_f32 v45, v98, v99
  v_rcp_f32 v102, v102
  v_cvt_pk_bf16_f32 v46, v100, v101
  v_rcp_f32 v103, v103
  v_mfma_f32_32x32x16_bf16 v[80:95], v[176:179], a[48:51], v[80:95]
  v_rcp_f32 v104, v104
  v_cvt_pk_bf16_f32 v47, v102, v103
  v_rcp_f32 v105, v105
  v_rcp_f32 v106, v106
  v_mfma_f32_16x16x32_bf16 v[32:35], v[44:47], a[144:147], v[32:35]
  v_cvt_pk_bf16_f32 v48, v104, v105
  v_rcp_f32 v107, v107
  v_mfma_f32_32x32x16_bf16 v[80:95], v[180:183], a[52:55], v[80:95]
  v_rcp_f32 v108, v108
  v_cvt_pk_bf16_f32 v49, v106, v107
  v_rcp_f32 v109, v109
  v_rcp_f32 v110, v110
  v_mfma_f32_32x32x16_bf16 v[80:95], v[184:187], a[56:59], v[80:95]
  v_cvt_pk_bf16_f32 v50, v108, v109
  v_rcp_f32 v111, v111
  v_exp_f32 v121, v121
  v_exp_f32 v122, v122
  v_mfma_f32_32x32x16_bf16 v[80:95], v[188:191], a[60:63], v[80:95]
  v_cvt_pk_bf16_f32 v51, v110, v111
  v_exp_f32 v123, v123
  v_exp_f32 v124, v124
  v_exp_f32 v125, v125
  v_mfma_f32_16x16x32_bf16 v[32:35], v[48:51], a[148:151], v[32:35]
  v_exp_f32 v126, v126
  v_mfma_f32_32x32x16_bf16 v[80:95], v[60:63], a[200:203], v[80:95]
  v_exp_f32 v127, v127
  ds_read_b64_tr_b16 a[108:109], v19 offset:8192
  ds_read_b64_tr_b16 a[110:111], v19 offset:8704
  ds_read_b64_tr_b16 a[112:113], v20 offset:8192
  v_mfma_f32_32x32x16_bf16 v[112:127], a[192:195], a[196:199], v[112:127]
  ds_read_b64_tr_b16 a[114:115], v20 offset:8704
  ds_read_b64_tr_b16 a[116:117], v21 offset:8192
  v_exp_f32 v64, v64
  v_exp_f32 v65, v65
  v_mfma_f32_32x32x16_bf16 v[96:111], v[192:195], a[32:35], 0
  v_exp_f32 v66, v66
  v_exp_f32 v67, v67
  v_exp_f32 v68, v68
  v_mfma_f32_32x32x16_bf16 v[96:111], v[196:199], a[36:39], v[96:111]
  v_exp_f32 v69, v69
  v_exp_f32 v70, v70
  v_exp_f32 v71, v71
  v_mfma_f32_32x32x16_bf16 v[96:111], v[200:203], a[40:43], v[96:111]
  v_rcp_f32 v112, v112
  v_rcp_f32 v113, v113
  v_rcp_f32 v114, v114
  v_mfma_f32_32x32x16_bf16 v[96:111], v[204:207], a[44:47], v[96:111]
  v_cvt_pk_bf16_f32 v44, v112, v113
  v_rcp_f32 v115, v115
  v_rcp_f32 v116, v116
  v_rcp_f32 v117, v117
  v_mfma_f32_32x32x16_bf16 v[96:111], v[208:211], a[48:51], v[96:111]
  v_cvt_pk_bf16_f32 v45, v114, v115
  v_rcp_f32 v118, v118
  v_cvt_pk_bf16_f32 v46, v116, v117
  v_rcp_f32 v119, v119
  v_mfma_f32_32x32x16_bf16 v[96:111], v[212:215], a[52:55], v[96:111]
  v_rcp_f32 v120, v120
  v_cvt_pk_bf16_f32 v47, v118, v119
  v_rcp_f32 v121, v121
  v_rcp_f32 v122, v122
  v_mfma_f32_16x16x32_bf16 v[32:35], v[44:47], a[152:155], v[32:35]
  v_cvt_pk_bf16_f32 v48, v120, v121
  v_rcp_f32 v123, v123
  v_mfma_f32_32x32x16_bf16 v[96:111], v[216:219], a[56:59], v[96:111]
  v_rcp_f32 v124, v124
  v_cvt_pk_bf16_f32 v49, v122, v123
  v_rcp_f32 v125, v125
  v_rcp_f32 v126, v126
  v_mfma_f32_32x32x16_bf16 v[96:111], v[220:223], a[60:63], v[96:111]
  v_cvt_pk_bf16_f32 v50, v124, v125
  v_rcp_f32 v127, v127
  v_exp_f32 v72, v72
  v_exp_f32 v73, v73
  v_mfma_f32_32x32x16_bf16 v[96:111], v[60:63], a[194:197], v[96:111]
  v_cvt_pk_bf16_f32 v51, v126, v127
  v_exp_f32 v74, v74
  v_exp_f32 v75, v75
  v_exp_f32 v76, v76
  v_mfma_f32_16x16x32_bf16 v[32:35], v[48:51], a[156:159], v[32:35]
  v_exp_f32 v77, v77
  v_mfma_f32_32x32x16_bf16 v[112:127], v[224:227], a[32:35], 0
  v_exp_f32 v78, v78
  v_exp_f32 v79, v79
  ds_read_b64_tr_b16 a[118:119], v21 offset:8704
  ds_read_b64_tr_b16 a[120:121], v22 offset:8192
  v_mfma_f32_32x32x16_bf16 v[112:127], v[228:231], a[36:39], v[112:127]
  ds_read_b64_tr_b16 a[122:123], v22 offset:8704
  s_waitcnt lgkmcnt(14)
  v_mul_legacy_f32 v32, v32, v36
  v_mul_legacy_f32 v33, v33, v37
  v_mul_legacy_f32 v34, v34, v38
  v_mul_legacy_f32 v35, v35, v39
  v_cvt_pk_bf16_f32 v40, v32, v33
  v_mfma_f32_32x32x16_bf16 v[64:79], a[192:195], a[196:199], v[64:79]
  v_cvt_pk_bf16_f32 v41, v34, v35
  v_mov_b32_dpp v42, v40 quad_perm:[1,0,3,2] row_mask:0xf bank_mask:0xf
  ds_read_b64_tr_b16 a[124:125], v23 offset:8192
  v_mov_b32_dpp v43, v41 quad_perm:[1,0,3,2] row_mask:0xf bank_mask:0xf
  ds_read_b64_tr_b16 a[126:127], v23 offset:8704
  v_mfma_f32_32x32x16_bf16 v[112:127], v[232:235], a[40:43], v[112:127]
  v_exp_f32 v80, v80
  v_exp_f32 v81, v81
  v_exp_f32 v82, v82
  v_mfma_f32_16x16x32_bf16 a[160:163], v[40:43], a[64:67], a[160:163]
  v_exp_f32 v83, v83
  v_mfma_f32_16x16x32_bf16 a[176:179], v[40:43], a[80:83], a[176:179]
  v_rcp_f32 v64, v64
  v_mfma_f32_16x16x32_bf16 a[164:167], v[40:43], a[68:71], a[164:167]
  v_rcp_f32 v65, v65
  v_mfma_f32_16x16x32_bf16 a[180:183], v[40:43], a[84:87], a[180:183]
  v_rcp_f32 v66, v66
  v_mfma_f32_16x16x32_bf16 a[168:171], v[40:43], a[72:75], a[168:171]
  v_cvt_pk_bf16_f32 v44, v64, v65
  v_rcp_f32 v67, v67
  v_mfma_f32_16x16x32_bf16 a[184:187], v[40:43], a[88:91], a[184:187]
  v_rcp_f32 v68, v68
  v_mfma_f32_16x16x32_bf16 a[172:175], v[40:43], a[76:79], a[172:175]
  v_cvt_pk_bf16_f32 v45, v66, v67
  v_rcp_f32 v69, v69
  v_mfma_f32_16x16x32_bf16 a[188:191], v[40:43], a[92:95], a[188:191]
  v_rcp_f32 v70, v70
  v_mfma_f32_32x32x16_bf16 v[112:127], v[236:239], a[44:47], v[112:127]
  v_cvt_pk_bf16_f32 v46, v68, v69
  v_rcp_f32 v71, v71
  v_rcp_f32 v72, v72
  v_rcp_f32 v73, v73
  v_mfma_f32_32x32x16_bf16 v[112:127], v[240:243], a[48:51], v[112:127]
  v_cvt_pk_bf16_f32 v47, v70, v71
  v_rcp_f32 v74, v74
  v_cvt_pk_bf16_f32 v48, v72, v73
  v_rcp_f32 v75, v75
  v_mfma_f32_16x16x32_bf16 v[32:35], v[44:47], a[128:131], v[28:31]
  v_rcp_f32 v76, v76
  v_mfma_f32_32x32x16_bf16 v[112:127], v[244:247], a[52:55], v[112:127]
  v_cvt_pk_bf16_f32 v49, v74, v75
  v_rcp_f32 v77, v77
  v_rcp_f32 v78, v78
  v_rcp_f32 v79, v79
  v_mfma_f32_32x32x16_bf16 v[112:127], v[248:251], a[56:59], v[112:127]
  v_cvt_pk_bf16_f32 v50, v76, v77
  v_exp_f32 v84, v84
  v_cvt_pk_bf16_f32 v51, v78, v79
  v_exp_f32 v85, v85
  v_mfma_f32_32x32x16_bf16 v[112:127], v[252:255], a[60:63], v[112:127]
  v_exp_f32 v86, v86
  v_exp_f32 v87, v87
  v_exp_f32 v88, v88
  v_mfma_f32_16x16x32_bf16 v[32:35], v[48:51], a[132:135], v[32:35]
  v_exp_f32 v89, v89
  v_mfma_f32_32x32x16_bf16 v[112:127], v[60:63], a[198:201], v[112:127]
  v_exp_f32 v90, v90
  v_exp_f32 v91, v91
  v_exp_f32 v92, v92
  v_exp_f32 v93, v93
  v_exp_f32 v94, v94
  v_exp_f32 v95, v95
  ds_read_b128 v[36:39], v52 offset:4736
  v_exp_f32 v96, v96
  v_exp_f32 v97, v97
  v_mfma_f32_32x32x16_bf16 v[80:95], a[192:195], a[196:199], v[80:95]
  v_exp_f32 v98, v98
  v_exp_f32 v99, v99
  v_exp_f32 v100, v100
  v_exp_f32 v101, v101
  v_exp_f32 v102, v102
  v_exp_f32 v103, v103
  v_exp_f32 v104, v104
  v_exp_f32 v105, v105
  v_exp_f32 v106, v106
  v_exp_f32 v107, v107
  v_exp_f32 v108, v108
  v_exp_f32 v109, v109
  v_exp_f32 v110, v110
  v_exp_f32 v111, v111
  v_rcp_f32 v80, v80
  v_rcp_f32 v81, v81
  v_rcp_f32 v82, v82
  v_mfma_f32_32x32x16_bf16 v[96:111], a[192:195], a[196:199], v[96:111]
  v_cvt_pk_bf16_f32 v44, v80, v81
  v_rcp_f32 v83, v83
  v_rcp_f32 v84, v84
  v_rcp_f32 v85, v85
  v_cvt_pk_bf16_f32 v45, v82, v83
  v_rcp_f32 v86, v86
  v_rcp_f32 v87, v87
  v_cvt_pk_bf16_f32 v46, v84, v85
  v_rcp_f32 v88, v88
  v_rcp_f32 v89, v89
  v_cvt_pk_bf16_f32 v47, v86, v87
  v_rcp_f32 v90, v90
  v_rcp_f32 v91, v91
  v_mfma_f32_16x16x32_bf16 v[32:35], v[44:47], a[136:139], v[32:35]
  v_cvt_pk_bf16_f32 v48, v88, v89
  v_rcp_f32 v92, v92
  v_cvt_pk_bf16_f32 v49, v90, v91
  v_rcp_f32 v93, v93
  v_rcp_f32 v94, v94
  v_rcp_f32 v95, v95
  v_cvt_pk_bf16_f32 v50, v92, v93
  v_exp_f32 v112, v112
  v_exp_f32 v113, v113
  v_cvt_pk_bf16_f32 v51, v94, v95
  v_exp_f32 v114, v114
  v_exp_f32 v115, v115
  v_mfma_f32_16x16x32_bf16 v[32:35], v[48:51], a[140:143], v[32:35]
  v_exp_f32 v116, v116
  v_exp_f32 v117, v117
  v_exp_f32 v118, v118
  v_exp_f32 v119, v119
  v_exp_f32 v120, v120
  v_exp_f32 v121, v121
  v_exp_f32 v122, v122
  v_exp_f32 v123, v123
  v_exp_f32 v124, v124
  v_exp_f32 v125, v125
  v_exp_f32 v126, v126
  v_exp_f32 v127, v127
  v_rcp_f32 v96, v96
  v_rcp_f32 v97, v97
  v_rcp_f32 v98, v98
  v_mfma_f32_32x32x16_bf16 v[112:127], a[192:195], a[196:199], v[112:127]
  v_cvt_pk_bf16_f32 v44, v96, v97
  v_rcp_f32 v99, v99
  v_rcp_f32 v100, v100
  v_rcp_f32 v101, v101
  v_cvt_pk_bf16_f32 v45, v98, v99
  v_rcp_f32 v102, v102
  v_rcp_f32 v103, v103
  v_cvt_pk_bf16_f32 v46, v100, v101
  v_rcp_f32 v104, v104
  v_rcp_f32 v105, v105
  v_cvt_pk_bf16_f32 v47, v102, v103
  v_rcp_f32 v106, v106
  v_rcp_f32 v107, v107
  v_mfma_f32_16x16x32_bf16 v[32:35], v[44:47], a[144:147], v[32:35]
  v_cvt_pk_bf16_f32 v48, v104, v105
  v_rcp_f32 v108, v108
  v_cvt_pk_bf16_f32 v49, v106, v107
  v_rcp_f32 v109, v109
  v_rcp_f32 v110, v110
  v_rcp_f32 v111, v111
  v_cvt_pk_bf16_f32 v50, v108, v109
  v_rcp_f32 v112, v112
  v_rcp_f32 v113, v113
  v_cvt_pk_bf16_f32 v51, v110, v111
  v_rcp_f32 v114, v114
  v_rcp_f32 v115, v115
  v_mfma_f32_16x16x32_bf16 v[32:35], v[48:51], a[148:151], v[32:35]
  v_cvt_pk_bf16_f32 v44, v112, v113
  v_rcp_f32 v116, v116
  v_cvt_pk_bf16_f32 v45, v114, v115
  v_rcp_f32 v117, v117
  v_rcp_f32 v118, v118
  v_rcp_f32 v119, v119
  v_cvt_pk_bf16_f32 v46, v116, v117
  v_rcp_f32 v120, v120
  v_rcp_f32 v121, v121
  v_cvt_pk_bf16_f32 v47, v118, v119
  v_rcp_f32 v122, v122
  v_rcp_f32 v123, v123
  v_mfma_f32_16x16x32_bf16 v[32:35], v[44:47], a[152:155], v[32:35]
  v_cvt_pk_bf16_f32 v48, v120, v121
  v_rcp_f32 v124, v124
  v_cvt_pk_bf16_f32 v49, v122, v123
  v_rcp_f32 v125, v125
  v_rcp_f32 v126, v126
  v_rcp_f32 v127, v127
  v_cvt_pk_bf16_f32 v50, v124, v125
  v_mbcnt_lo_u32_b32 v66, -1, 0
  v_mbcnt_hi_u32_b32 v66, -1, v66
  v_cvt_pk_bf16_f32 v51, v126, v127
  v_lshlrev_b32 v66, 1, v66
  s_nop 0
  v_mfma_f32_16x16x32_bf16 v[32:35], v[48:51], a[156:159], v[32:35]
  s_waitcnt lgkmcnt(0)
  s_nop 6
  v_mul_legacy_f32 v32, v32, v36
  v_mul_legacy_f32 v33, v33, v37
  v_mul_legacy_f32 v34, v34, v38
  v_mul_legacy_f32 v35, v35, v39
  v_cvt_pk_bf16_f32 v40, v32, v33
  v_cvt_pk_bf16_f32 v41, v34, v35
  s_nop 0
  v_mov_b32_dpp v42, v40 quad_perm:[1,0,3,2] row_mask:0xf bank_mask:0xf
  v_mov_b32_dpp v43, v41 quad_perm:[1,0,3,2] row_mask:0xf bank_mask:0xf
  s_nop 1
  v_mfma_f32_16x16x32_bf16 a[160:163], v[40:43], a[96:99], a[160:163]
  v_mfma_f32_16x16x32_bf16 a[176:179], v[40:43], a[112:115], a[176:179]
  v_mfma_f32_16x16x32_bf16 a[164:167], v[40:43], a[100:103], a[164:167]
  v_mfma_f32_16x16x32_bf16 a[180:183], v[40:43], a[116:119], a[180:183]
  v_mfma_f32_16x16x32_bf16 a[168:171], v[40:43], a[104:107], a[168:171]
  v_mfma_f32_16x16x32_bf16 a[184:187], v[40:43], a[120:123], a[184:187]
  v_mfma_f32_16x16x32_bf16 a[172:175], v[40:43], a[108:111], a[172:175]
  v_mfma_f32_16x16x32_bf16 a[188:191], v[40:43], a[124:127], a[188:191]
  s_nop 0
  v_accvgpr_read_b32 v68, a160
  v_accvgpr_read_b32 v69, a176
  v_cvt_pk_bf16_f32 v64, v68, v69
  v_accvgpr_read_b32 v70, a164
  v_accvgpr_read_b32 v71, a180
  v_cvt_pk_bf16_f32 v70, v70, v71
  v_accvgpr_read_b32 v72, a168
  v_accvgpr_read_b32 v73, a184
  v_mov_b32_dpp v64, v70 quad_perm:[0,1,2,3] row_mask:0x2 bank_mask:0xf
  v_cvt_pk_bf16_f32 v72, v72, v73
  v_accvgpr_read_b32 v74, a172
  v_accvgpr_read_b32 v75, a188
  v_mov_b32_dpp v64, v72 quad_perm:[0,1,2,3] row_mask:0x4 bank_mask:0xf
  v_cvt_pk_bf16_f32 v74, v74, v75
  s_nop 1
  v_mov_b32_dpp v64, v74 quad_perm:[0,1,2,3] row_mask:0x8 bank_mask:0xf
  s_branch L_store
L_t7:
  v_mfma_f32_32x32x16_bf16 v[112:127], v[224:227], a[32:35], 0
  s_waitcnt vmcnt(8)
  ds_read_b128 a[0:3], v8 offset:16384
  s_nop 3
  v_rcp_f32 v80, v80
  v_rcp_f32 v81, v81
  v_mfma_f32_32x32x16_bf16 v[112:127], v[228:231], a[36:39], v[112:127]
  ds_read_b128 v[0:3], v53 offset:512
  v_cvt_pk_bf16_f32 v44, v80, v81
  v_rcp_f32 v82, v82
  ds_read_b128 a[4:7], v9 offset:16384
  v_mfma_f32_32x32x16_bf16 v[112:127], v[232:235], a[40:43], v[112:127]
  v_rcp_f32 v83, v83
  v_rcp_f32 v84, v84
  v_rcp_f32 v85, v85
  v_mfma_f32_32x32x16_bf16 v[112:127], v[236:239], a[44:47], v[112:127]
  v_cvt_pk_bf16_f32 v45, v82, v83
  ds_read_b128 a[8:11], v10 offset:16384
  v_cvt_pk_bf16_f32 v46, v84, v85
  v_rcp_f32 v86, v86
  v_mfma_f32_32x32x16_bf16 v[112:127], v[240:243], a[48:51], v[112:127]
  v_rcp_f32 v87, v87
  v_rcp_f32 v88, v88
  ds_read_b128 a[12:15], v11 offset:16384
  v_cvt_pk_bf16_f32 v47, v86, v87
  v_mfma_f32_32x32x16_bf16 v[112:127], v[244:247], a[52:55], v[112:127]
  s_add_u32 m0, s14, 0
  v_rcp_f32 v89, v89
  ds_read_b128 a[16:19], v12 offset:16384
  v_rcp_f32 v90, v90
  v_mfma_f32_16x16x32_bf16 v[32:35], v[44:47], a[136:139], v[32:35]
  s_waitcnt lgkmcnt(4)
  v_xad_u32 v0, v54, 0, v0
  buffer_load_dwordx4 v0, s[36:39], s52 offen offset:0 nt lds
  v_mfma_f32_32x32x16_bf16 v[112:127], v[248:251], a[56:59], v[112:127]
  v_cvt_pk_bf16_f32 v48, v88, v89
  v_rcp_f32 v91, v91
  v_rcp_f32 v92, v92
  v_rcp_f32 v93, v93
  v_mfma_f32_32x32x16_bf16 v[112:127], v[252:255], a[60:63], v[112:127]
  v_cvt_pk_bf16_f32 v49, v90, v91
  ds_read_b128 a[20:23], v13 offset:16384
  v_cvt_pk_bf16_f32 v50, v92, v93
  v_rcp_f32 v94, v94
  v_mfma_f32_32x32x16_bf16 v[112:127], v[60:63], a[198:201], v[112:127]
  v_rcp_f32 v95, v95
  ds_read_b128 a[24:27], v14 offset:16384
  v_xad_u32 v1, v54, 32, v1
  buffer_load_dwordx4 v1, s[36:39], s53 offen offset:1024 nt lds
  v_mfma_f32_32x32x16_bf16 v[64:79], v[128:131], a[0:3], 0
  v_cvt_pk_bf16_f32 v51, v94, v95
  v_exp_f32 v96, v96
  v_exp_f32 v97, v97
  v_exp_f32 v98, v98
  v_mfma_f32_16x16x32_bf16 v[32:35], v[48:51], a[140:143], v[32:35]
  ds_read_b128 a[28:31], v15 offset:16384
  v_exp_f32 v99, v99
  s_waitcnt lgkmcnt(6)
  v_mfma_f32_32x32x16_bf16 v[64:79], v[132:135], a[4:7], v[64:79]
  v_exp_f32 v100, v100
  v_exp_f32 v101, v101
  v_exp_f32 v102, v102
  s_waitcnt lgkmcnt(5)
  v_mfma_f32_32x32x16_bf16 v[64:79], v[136:139], a[8:11], v[64:79]
  v_exp_f32 v103, v103
  ds_read_b128 v[36:39], v52 offset:4224
  v_exp_f32 v104, v104
  v_exp_f32 v105, v105
  s_waitcnt lgkmcnt(5)
  v_mfma_f32_32x32x16_bf16 v[64:79], v[140:143], a[12:15], v[64:79]
  v_exp_f32 v106, v106
  v_exp_f32 v107, v107
  v_exp_f32 v108, v108
  s_waitcnt lgkmcnt(4)
  v_mfma_f32_32x32x16_bf16 v[64:79], v[144:147], a[16:19], v[64:79]
  v_exp_f32 v109, v109
  v_exp_f32 v110, v110
  v_exp_f32 v111, v111
  s_waitcnt lgkmcnt(3)
  v_mfma_f32_32x32x16_bf16 v[64:79], v[148:151], a[20:23], v[64:79]
  ds_read_b64_tr_b16 a[64:65], v16 offset:16384
  v_xad_u32 v2, v54, 64, v2
  buffer_load_dwordx4 v2, s[36:39], s54 offen offset:2048 nt lds
  v_mfma_f32_32x32x16_bf16 v[96:111], a[192:195], a[196:199], v[96:111]
  ds_read_b64_tr_b16 a[66:67], v16 offset:16896
  ds_read_b64_tr_b16 a[68:69], v17 offset:16384
  ds_read_b64_tr_b16 a[70:71], v17 offset:16896
  v_xad_u32 v3, v54, s55, v3
  s_waitcnt lgkmcnt(6)
  v_mfma_f32_32x32x16_bf16 v[64:79], v[152:155], a[24:27], v[64:79]
  ds_read_b64_tr_b16 a[72:73], v18 offset:16384
  ds_read_b64_tr_b16 a[74:75], v18 offset:16896
  v_exp_f32 v112, v112
  v_exp_f32 v113, v113
  s_waitcnt lgkmcnt(7)
  v_mfma_f32_32x32x16_bf16 v[64:79], v[156:159], a[28:31], v[64:79]
  buffer_load_dwordx4 v3, s[36:39], 0 offen offset:3072 nt lds
  v_exp_f32 v114, v114
  v_rcp_f32 v96, v96
  v_mfma_f32_32x32x16_bf16 v[64:79], v[60:63], a[196:199], v[64:79]
  v_rcp_f32 v97, v97
  v_rcp_f32 v98, v98
  v_rcp_f32 v99, v99
  v_mfma_f32_32x32x16_bf16 v[80:95], v[160:163], a[0:3], 0
  v_cvt_pk_bf16_f32 v44, v96, v97
  v_rcp_f32 v100, v100
  v_cvt_pk_bf16_f32 v45, v98, v99
  v_rcp_f32 v101, v101
  v_mfma_f32_32x32x16_bf16 v[80:95], v[164:167], a[4:7], v[80:95]
  v_rcp_f32 v102, v102
  v_cvt_pk_bf16_f32 v46, v100, v101
  v_rcp_f32 v103, v103
  v_rcp_f32 v104, v104
  v_mfma_f32_32x32x16_bf16 v[80:95], v[168:171], a[8:11], v[80:95]
  v_cvt_pk_bf16_f32 v47, v102, v103
  v_rcp_f32 v105, v105
  v_rcp_f32 v106, v106
  v_rcp_f32 v107, v107
  v_mfma_f32_16x16x32_bf16 v[32:35], v[44:47], a[144:147], v[32:35]
  v_cvt_pk_bf16_f32 v48, v104, v105
  v_rcp_f32 v108, v108
  v_mfma_f32_32x32x16_bf16 v[80:95], v[172:175], a[12:15], v[80:95]
  v_cvt_pk_bf16_f32 v49, v106, v107
  v_rcp_f32 v109, v109
  v_rcp_f32 v110, v110
  v_rcp_f32 v111, v111
  v_mfma_f32_32x32x16_bf16 v[80:95], v[176:179], a[16:19], v[80:95]
  v_cvt_pk_bf16_f32 v50, v108, v109
  v_exp_f32 v115, v115
  v_cvt_pk_bf16_f32 v51, v110, v111
  v_exp_f32 v116, v116
  v_mfma_f32_32x32x16_bf16 v[80:95], v[180:183], a[20:23], v[80:95]
  v_exp_f32 v117, v117
  v_exp_f32 v118, v118
  v_exp_f32 v119, v119
  v_mfma_f32_16x16x32_bf16 v[32:35], v[48:51], a[148:151], v[32:35]
  v_exp_f32 v120, v120
  v_mfma_f32_32x32x16_bf16 v[80:95], v[184:187], a[24:27], v[80:95]
  v_exp_f32 v121, v121
  v_exp_f32 v122, v122
  v_exp_f32 v123, v123
  v_mfma_f32_32x32x16_bf16 v[80:95], v[188:191], a[28:31], v[80:95]
  v_exp_f32 v124, v124
  v_exp_f32 v125, v125
  v_exp_f32 v126, v126
  v_mfma_f32_32x32x16_bf16 v[80:95], v[60:63], a[200:203], v[80:95]
  v_exp_f32 v127, v127
  ds_read_b64_tr_b16 a[76:77], v19 offset:16384
  ds_read_b128 v[4:7], v53 offset:528
  s_add_u32 m0, s14, 4096
  v_mfma_f32_32x32x16_bf16 v[96:111], v[192:195], a[0:3], 0
  ds_read_b64_tr_b16 a[78:79], v19 offset:16896
  ds_read_b64_tr_b16 a[80:81], v20 offset:16384
  ds_read_b64_tr_b16 a[82:83], v20 offset:16896
  ds_read_b64_tr_b16 a[84:85], v21 offset:16384
  v_mfma_f32_32x32x16_bf16 v[112:127], a[192:195], a[196:199], v[112:127]
  v_exp_f32 v64, v64
  v_exp_f32 v65, v65
  v_exp_f32 v66, v66
  v_mfma_f32_32x32x16_bf16 v[96:111], v[196:199], a[4:7], v[96:111]
  v_exp_f32 v67, v67
  v_exp_f32 v68, v68
  v_exp_f32 v69, v69
  v_mfma_f32_32x32x16_bf16 v[96:111], v[200:203], a[8:11], v[96:111]
  v_exp_f32 v70, v70
  v_exp_f32 v71, v71
  v_exp_f32 v72, v72
  v_mfma_f32_32x32x16_bf16 v[96:111], v[204:207], a[12:15], v[96:111]
  v_rcp_f32 v112, v112
  v_rcp_f32 v113, v113
  v_rcp_f32 v114, v114
  v_mfma_f32_32x32x16_bf16 v[96:111], v[208:211], a[16:19], v[96:111]
  v_cvt_pk_bf16_f32 v44, v112, v113
  v_rcp_f32 v115, v115
  v_rcp_f32 v116, v116
  v_rcp_f32 v117, v117
  v_mfma_f32_32x32x16_bf16 v[96:111], v[212:215], a[20:23], v[96:111]
  v_cvt_pk_bf16_f32 v45, v114, v115
  v_rcp_f32 v118, v118
  v_cvt_pk_bf16_f32 v46, v116, v117
  v_rcp_f32 v119, v119
  v_mfma_f32_32x32x16_bf16 v[96:111], v[216:219], a[24:27], v[96:111]
  v_rcp_f32 v120, v120
  v_cvt_pk_bf16_f32 v47, v118, v119
  s_waitcnt lgkmcnt(4)
  v_xad_u32 v4, v54, s72, v4
  buffer_load_dwordx4 v4, s[36:39], s52 offen offset:0 nt lds
  v_mfma_f32_16x16x32_bf16 v[32:35], v[44:47], a[152:155], v[32:35]
  v_rcp_f32 v121, v121
  v_mfma_f32_32x32x16_bf16 v[96:111], v[220:223], a[28:31], v[96:111]
  v_rcp_f32 v122, v122
  v_cvt_pk_bf16_f32 v48, v120, v121
  v_rcp_f32 v123, v123
  v_rcp_f32 v124, v124
  v_mfma_f32_32x32x16_bf16 v[96:111], v[60:63], a[194:197], v[96:111]
  v_cvt_pk_bf16_f32 v49, v122, v123
  v_rcp_f32 v125, v125
  v_rcp_f32 v126, v126
  v_rcp_f32 v127, v127
  v_cvt_pk_bf16_f32 v50, v124, v125
  v_xad_u32 v5, v54, s73, v5
  buffer_load_dwordx4 v5, s[36:39], s53 offen offset:1024 nt lds
  v_cvt_pk_bf16_f32 v51, v126, v127
  v_mfma_f32_32x32x16_bf16 v[112:127], v[224:227], a[0:3], 0
  v_exp_f32 v73, v73
  v_exp_f32 v74, v74
  v_exp_f32 v75, v75
  v_mfma_f32_16x16x32_bf16 v[32:35], v[48:51], a[156:159], v[32:35]
  v_exp_f32 v76, v76
  v_mfma_f32_32x32x16_bf16 v[112:127], v[228:231], a[4:7], v[112:127]
  v_exp_f32 v77, v77
  v_exp_f32 v78, v78
  v_exp_f32 v79, v79
  v_mfma_f32_32x32x16_bf16 v[112:127], v[232:235], a[8:11], v[112:127]
  ds_read_b64_tr_b16 a[86:87], v21 offset:16896
  v_xad_u32 v6, v54, s74, v6
  v_mul_legacy_f32 v32, v32, v36
  v_mul_legacy_f32 v33, v33, v37
  v_mul_legacy_f32 v34, v34, v38
  v_mfma_f32_32x32x16_bf16 v[64:79], a[192:195], a[196:199], v[64:79]
  v_mul_legacy_f32 v35, v35, v39
  v_cvt_pk_bf16_f32 v40, v32, v33
  v_cvt_pk_bf16_f32 v41, v34, v35
  buffer_load_dwordx4 v6, s[36:39], s54 offen offset:2048 nt lds
  v_mfma_f32_32x32x16_bf16 v[112:127], v[236:239], a[12:15], v[112:127]
  v_mov_b32_dpp v42, v40 quad_perm:[1,0,3,2] row_mask:0xf bank_mask:0xf
  v_mov_b32_dpp v43, v41 quad_perm:[1,0,3,2] row_mask:0xf bank_mask:0xf
  ds_read_b64_tr_b16 a[88:89], v22 offset:16384
  ds_read_b64_tr_b16 a[90:91], v22 offset:16896
  v_mfma_f32_16x16x32_bf16 a[160:163], v[40:43], a[96:99], a[160:163]
  ds_read_b64_tr_b16 a[92:93], v23 offset:16384
  v_xad_u32 v7, v54, s11, v7
  v_mfma_f32_16x16x32_bf16 a[176:179], v[40:43], a[112:115], a[176:179]
  v_rcp_f32 v64, v64
  v_mfma_f32_16x16x32_bf16 a[164:167], v[40:43], a[100:103], a[164:167]
  v_rcp_f32 v65, v65
  v_mfma_f32_16x16x32_bf16 a[180:183], v[40:43], a[116:119], a[180:183]
  v_rcp_f32 v66, v66
  v_mfma_f32_16x16x32_bf16 a[168:171], v[40:43], a[104:107], a[168:171]
  v_cvt_pk_bf16_f32 v44, v64, v65
  v_rcp_f32 v67, v67
  v_mfma_f32_16x16x32_bf16 a[184:187], v[40:43], a[120:123], a[184:187]
  v_rcp_f32 v68, v68
  v_mfma_f32_16x16x32_bf16 a[172:175], v[40:43], a[108:111], a[172:175]
  v_cvt_pk_bf16_f32 v45, v66, v67
  v_rcp_f32 v69, v69
  v_mfma_f32_16x16x32_bf16 a[188:191], v[40:43], a[124:127], a[188:191]
  v_rcp_f32 v70, v70
  v_mfma_f32_32x32x16_bf16 v[112:127], v[240:243], a[16:19], v[112:127]
  v_cvt_pk_bf16_f32 v46, v68, v69
  v_rcp_f32 v71, v71
  v_rcp_f32 v72, v72
  buffer_load_dwordx4 v7, s[36:39], 0 offen offset:3072 nt lds
  v_mfma_f32_32x32x16_bf16 v[112:127], v[244:247], a[20:23], v[112:127]
  v_cvt_pk_bf16_f32 v47, v70, v71
  v_rcp_f32 v73, v73
  ds_read_b64_tr_b16 a[94:95], v23 offset:16896
  v_rcp_f32 v74, v74
  v_mfma_f32_16x16x32_bf16 v[32:35], v[44:47], a[128:131], v[28:31]
  v_cvt_pk_bf16_f32 v48, v72, v73
  v_rcp_f32 v75, v75
  v_mfma_f32_32x32x16_bf16 v[112:127], v[248:251], a[24:27], v[112:127]
  v_rcp_f32 v76, v76
  v_cvt_pk_bf16_f32 v49, v74, v75
  v_rcp_f32 v77, v77
  v_rcp_f32 v78, v78
  v_mfma_f32_32x32x16_bf16 v[112:127], v[252:255], a[28:31], v[112:127]
  v_cvt_pk_bf16_f32 v50, v76, v77
  v_rcp_f32 v79, v79
  v_exp_f32 v80, v80
  v_exp_f32 v81, v81
  v_mfma_f32_32x32x16_bf16 v[112:127], v[60:63], a[198:201], v[112:127]
  v_cvt_pk_bf16_f32 v51, v78, v79
  v_exp_f32 v82, v82
  v_exp_f32 v83, v83
  v_exp_f32 v84, v84
  v_mfma_f32_16x16x32_bf16 v[32:35], v[48:51], a[132:135], v[32:35]
  v_exp_f32 v85, v85
  v_exp_f32 v86, v86
  v_exp_f32 v87, v87
  v_exp_f32 v88, v88
  v_exp_f32 v89, v89
  v_exp_f32 v90, v90
  v_exp_f32 v91, v91
  v_exp_f32 v92, v92
  v_exp_f32 v93, v93
  v_exp_f32 v94, v94
  v_exp_f32 v95, v95
  s_waitcnt vmcnt(8)
  ds_read_b128 a[32:35], v8 offset:24576
  s_add_u32 m0, s14, 8192
  v_exp_f32 v96, v96
  v_mfma_f32_32x32x16_bf16 v[80:95], a[192:195], a[196:199], v[80:95]
  ds_read_b128 v[0:3], v53 offset:640
  v_exp_f32 v97, v97
  ds_read_b128 a[36:39], v9 offset:24576
  v_exp_f32 v98, v98
  ds_read_b128 a[40:43], v10 offset:24576
  v_exp_f32 v99, v99
  ds_read_b128 a[44:47], v11 offset:24576
  v_exp_f32 v100, v100
  ds_read_b128 a[48:51], v12 offset:24576
  v_exp_f32 v101, v101
  ds_read_b128 a[52:55], v13 offset:24576
  v_exp_f32 v102, v102
  v_rcp_f32 v80, v80
  v_rcp_f32 v81, v81
  v_rcp_f32 v82, v82
  v_rcp_f32 v83, v83
  v_cvt_pk_bf16_f32 v44, v80, v81
  v_rcp_f32 v84, v84
  s_waitcnt lgkmcnt(6)
  v_mfma_f32_32x32x16_bf16 v[64:79], v[128:131], a[32:35], 0
  v_cvt_pk_bf16_f32 v45, v82, v83
  v_rcp_f32 v85, v85
  v_rcp_f32 v86, v86
  v_rcp_f32 v87, v87
  v_cvt_pk_bf16_f32 v46, v84, v85
  s_waitcnt lgkmcnt(4)
  v_mfma_f32_32x32x16_bf16 v[64:79], v[132:135], a[36:39], v[64:79]
  v_rcp_f32 v88, v88
  v_cvt_pk_bf16_f32 v47, v86, v87
  v_xad_u32 v0, v54, 0, v0
  buffer_load_dwordx4 v0, s[36:39], s52 offen offset:0 nt lds
  v_mfma_f32_16x16x32_bf16 v[32:35], v[44:47], a[136:139], v[32:35]
  v_rcp_f32 v89, v89
  s_waitcnt lgkmcnt(3)
  v_mfma_f32_32x32x16_bf16 v[64:79], v[136:139], a[40:43], v[64:79]
  v_rcp_f32 v90, v90
  v_cvt_pk_bf16_f32 v48, v88, v89
  v_rcp_f32 v91, v91
  v_rcp_f32 v92, v92
  s_waitcnt lgkmcnt(2)
  v_mfma_f32_32x32x16_bf16 v[64:79], v[140:143], a[44:47], v[64:79]
  v_cvt_pk_bf16_f32 v49, v90, v91
  v_rcp_f32 v93, v93
  v_rcp_f32 v94, v94
  v_rcp_f32 v95, v95
  s_waitcnt lgkmcnt(1)
  v_mfma_f32_32x32x16_bf16 v[64:79], v[144:147], a[48:51], v[64:79]
  v_cvt_pk_bf16_f32 v50, v92, v93
  ds_read_b128 a[56:59], v14 offset:24576
  v_cvt_pk_bf16_f32 v51, v94, v95
  v_xad_u32 v1, v54, 32, v1
  buffer_load_dwordx4 v1, s[36:39], s53 offen offset:1024 nt lds
  v_mfma_f32_16x16x32_bf16 v[32:35], v[48:51], a[140:143], v[32:35]
  ds_read_b128 a[60:63], v15 offset:24576
  v_exp_f32 v103, v103
  s_waitcnt lgkmcnt(2)
  v_mfma_f32_32x32x16_bf16 v[64:79], v[148:151], a[52:55], v[64:79]
  ds_read_b128 v[36:39], v52 offset:4352
  v_exp_f32 v104, v104
  v_exp_f32 v105, v105
  v_exp_f32 v106, v106
  v_mfma_f32_32x32x16_bf16 v[80:95], v[160:163], a[32:35], 0
  v_exp_f32 v107, v107
  v_exp_f32 v108, v108
  v_exp_f32 v109, v109
  v_mfma_f32_32x32x16_bf16 v[80:95], v[164:167], a[36:39], v[80:95]
  v_exp_f32 v110, v110
  v_exp_f32 v111, v111
  ds_read_b64_tr_b16 a[96:97], v16 offset:24576
  v_xad_u32 v2, v54, 64, v2
  v_mfma_f32_32x32x16_bf16 v[80:95], v[168:171], a[40:43], v[80:95]
  buffer_load_dwordx4 v2, s[36:39], s54 offen offset:2048 nt lds
  ds_read_b64_tr_b16 a[98:99], v16 offset:25088
  ds_read_b64_tr_b16 a[100:101], v17 offset:24576
  v_mfma_f32_32x32x16_bf16 v[96:111], a[192:195], a[196:199], v[96:111]
  ds_read_b64_tr_b16 a[102:103], v17 offset:25088
  v_xad_u32 v3, v54, s55, v3
  ds_read_b64_tr_b16 a[104:105], v18 offset:24576
  ds_read_b64_tr_b16 a[106:107], v18 offset:25088
  s_waitcnt lgkmcnt(8)
  v_mfma_f32_32x32x16_bf16 v[64:79], v[152:155], a[56:59], v[64:79]
  v_exp_f32 v112, v112
  v_exp_f32 v113, v113
  buffer_load_dwordx4 v3, s[36:39], 0 offen offset:3072 nt lds
  s_waitcnt lgkmcnt(7)
  v_mfma_f32_32x32x16_bf16 v[64:79], v[156:159], a[60:63], v[64:79]
  v_exp_f32 v114, v114
  v_exp_f32 v115, v115
  v_exp_f32 v116, v116
  v_mfma_f32_32x32x16_bf16 v[64:79], v[60:63], a[196:199], v[64:79]
  v_rcp_f32 v96, v96
  v_rcp_f32 v97, v97
  v_rcp_f32 v98, v98
  v_mfma_f32_32x32x16_bf16 v[80:95], v[172:175], a[44:47], v[80:95]
  v_cvt_pk_bf16_f32 v44, v96, v97
  v_rcp_f32 v99, v99
  v_rcp_f32 v100, v100
  v_rcp_f32 v101, v101
  v_mfma_f32_32x32x16_bf16 v[80:95], v[176:179], a[48:51], v[80:95]
  v_cvt_pk_bf16_f32 v45, v98, v99
  v_rcp_f32 v102, v102
  v_cvt_pk_bf16_f32 v46, v100, v101
  v_rcp_f32 v103, v103
  v_mfma_f32_32x32x16_bf16 v[80:95], v[180:183], a[52:55], v[80:95]
  v_rcp_f32 v104, v104
  v_cvt_pk_bf16_f32 v47, v102, v103
  v_rcp_f32 v105, v105
  v_rcp_f32 v106, v106
  v_mfma_f32_16x16x32_bf16 v[32:35], v[44:47], a[144:147], v[32:35]
  v_cvt_pk_bf16_f32 v48, v104, v105
  v_rcp_f32 v107, v107
  v_mfma_f32_32x32x16_bf16 v[80:95], v[184:187], a[56:59], v[80:95]
  v_rcp_f32 v108, v108
  v_cvt_pk_bf16_f32 v49, v106, v107
  v_rcp_f32 v109, v109
  v_rcp_f32 v110, v110
  v_mfma_f32_32x32x16_bf16 v[80:95], v[188:191], a[60:63], v[80:95]
  v_cvt_pk_bf16_f32 v50, v108, v109
  v_rcp_f32 v111, v111
  v_exp_f32 v117, v117
  v_exp_f32 v118, v118
  v_mfma_f32_32x32x16_bf16 v[80:95], v[60:63], a[200:203], v[80:95]
  v_cvt_pk_bf16_f32 v51, v110, v111
  v_exp_f32 v119, v119
  v_exp_f32 v120, v120
  v_exp_f32 v121, v121
  v_mfma_f32_16x16x32_bf16 v[32:35], v[48:51], a[148:151], v[32:35]
  v_exp_f32 v122, v122
  v_mfma_f32_32x32x16_bf16 v[96:111], v[192:195], a[32:35], 0
  v_exp_f32 v123, v123
  v_exp_f32 v124, v124
  v_exp_f32 v125, v125
  v_mfma_f32_32x32x16_bf16 v[96:111], v[196:199], a[36:39], v[96:111]
  v_exp_f32 v126, v126
  v_exp_f32 v127, v127
  ds_read_b64_tr_b16 a[108:109], v19 offset:24576
  ds_read_b128 v[4:7], v53 offset:656
  v_mfma_f32_32x32x16_bf16 v[96:111], v[200:203], a[40:43], v[96:111]
  ds_read_b64_tr_b16 a[110:111], v19 offset:25088
  ds_read_b64_tr_b16 a[112:113], v20 offset:24576
  ds_read_b64_tr_b16 a[114:115], v20 offset:25088
  s_add_u32 m0, s14, 12288
  v_mfma_f32_32x32x16_bf16 v[112:127], a[192:195], a[196:199], v[112:127]
  ds_read_b64_tr_b16 a[116:117], v21 offset:24576
  v_exp_f32 v64, v64
  v_exp_f32 v65, v65
  v_exp_f32 v66, v66
  v_mfma_f32_32x32x16_bf16 v[96:111], v[204:207], a[44:47], v[96:111]
  v_exp_f32 v67, v67
  v_exp_f32 v68, v68
  v_exp_f32 v69, v69
  v_mfma_f32_32x32x16_bf16 v[96:111], v[208:211], a[48:51], v[96:111]
  v_exp_f32 v70, v70
  v_exp_f32 v71, v71
  v_exp_f32 v72, v72
  v_mfma_f32_32x32x16_bf16 v[96:111], v[212:215], a[52:55], v[96:111]
  v_rcp_f32 v112, v112
  v_rcp_f32 v113, v113
  v_rcp_f32 v114, v114
  v_mfma_f32_32x32x16_bf16 v[96:111], v[216:219], a[56:59], v[96:111]
  v_cvt_pk_bf16_f32 v44, v112, v113
  v_rcp_f32 v115, v115
  v_rcp_f32 v116, v116
  v_rcp_f32 v117, v117
  v_mfma_f32_32x32x16_bf16 v[96:111], v[220:223], a[60:63], v[96:111]
  v_cvt_pk_bf16_f32 v45, v114, v115
  v_rcp_f32 v118, v118
  v_cvt_pk_bf16_f32 v46, v116, v117
  v_rcp_f32 v119, v119
  v_mfma_f32_32x32x16_bf16 v[96:111], v[60:63], a[194:197], v[96:111]
  v_rcp_f32 v120, v120
  v_cvt_pk_bf16_f32 v47, v118, v119
  s_waitcnt lgkmcnt(4)
  v_xad_u32 v4, v54, s72, v4
  buffer_load_dwordx4 v4, s[36:39], s52 offen offset:0 nt lds
  v_mfma_f32_16x16x32_bf16 v[32:35], v[44:47], a[152:155], v[32:35]
  v_rcp_f32 v121, v121
  v_rcp_f32 v122, v122
  v_rcp_f32 v123, v123
  v_cvt_pk_bf16_f32 v48, v120, v121
  v_rcp_f32 v124, v124
  v_rcp_f32 v125, v125
  v_cvt_pk_bf16_f32 v49, v122, v123
  v_rcp_f32 v126, v126
  v_rcp_f32 v127, v127
  v_cvt_pk_bf16_f32 v50, v124, v125
  v_xad_u32 v5, v54, s73, v5
  buffer_load_dwordx4 v5, s[36:39], s53 offen offset:1024 nt lds
  v_cvt_pk_bf16_f32 v51, v126, v127
  v_mfma_f32_32x32x16_bf16 v[112:127], v[224:227], a[32:35], 0
  v_exp_f32 v73, v73
  v_exp_f32 v74, v74
  v_exp_f32 v75, v75
  v_mfma_f32_16x16x32_bf16 v[32:35], v[48:51], a[156:159], v[32:35]
  v_exp_f32 v76, v76
  v_mfma_f32_32x32x16_bf16 v[112:127], v[228:231], a[36:39], v[112:127]
  v_exp_f32 v77, v77
  v_exp_f32 v78, v78
  v_exp_f32 v79, v79
  v_mfma_f32_32x32x16_bf16 v[112:127], v[232:235], a[40:43], v[112:127]
  ds_read_b64_tr_b16 a[118:119], v21 offset:25088
  v_xad_u32 v6, v54, s74, v6
  v_mul_legacy_f32 v32, v32, v36
  v_mul_legacy_f32 v33, v33, v37
  v_mul_legacy_f32 v34, v34, v38
  v_mfma_f32_32x32x16_bf16 v[64:79], a[192:195], a[196:199], v[64:79]
  v_mul_legacy_f32 v35, v35, v39
  v_cvt_pk_bf16_f32 v40, v32, v33
  v_cvt_pk_bf16_f32 v41, v34, v35
  buffer_load_dwordx4 v6, s[36:39], s54 offen offset:2048 nt lds
  v_mfma_f32_32x32x16_bf16 v[112:127], v[236:239], a[44:47], v[112:127]
  v_mov_b32_dpp v42, v40 quad_perm:[1,0,3,2] row_mask:0xf bank_mask:0xf
  v_mov_b32_dpp v43, v41 quad_perm:[1,0,3,2] row_mask:0xf bank_mask:0xf
  ds_read_b64_tr_b16 a[120:121], v22 offset:24576
  ds_read_b64_tr_b16 a[122:123], v22 offset:25088
  v_mfma_f32_16x16x32_bf16 a[160:163], v[40:43], a[64:67], a[160:163]
  ds_read_b64_tr_b16 a[124:125], v23 offset:24576
  v_xad_u32 v7, v54, s11, v7
  v_mfma_f32_16x16x32_bf16 a[176:179], v[40:43], a[80:83], a[176:179]
  v_rcp_f32 v64, v64
  v_mfma_f32_16x16x32_bf16 a[164:167], v[40:43], a[68:71], a[164:167]
  v_rcp_f32 v65, v65
  v_mfma_f32_16x16x32_bf16 a[180:183], v[40:43], a[84:87], a[180:183]
  v_rcp_f32 v66, v66
  v_mfma_f32_16x16x32_bf16 a[168:171], v[40:43], a[72:75], a[168:171]
  v_cvt_pk_bf16_f32 v44, v64, v65
  v_rcp_f32 v67, v67
  v_mfma_f32_16x16x32_bf16 a[184:187], v[40:43], a[88:91], a[184:187]
  v_rcp_f32 v68, v68
  v_mfma_f32_16x16x32_bf16 a[172:175], v[40:43], a[76:79], a[172:175]
  v_cvt_pk_bf16_f32 v45, v66, v67
  v_rcp_f32 v69, v69
  v_mfma_f32_16x16x32_bf16 a[188:191], v[40:43], a[92:95], a[188:191]
  v_rcp_f32 v70, v70
  v_mfma_f32_32x32x16_bf16 v[112:127], v[240:243], a[48:51], v[112:127]
  v_cvt_pk_bf16_f32 v46, v68, v69
  v_rcp_f32 v71, v71
  v_rcp_f32 v72, v72
  buffer_load_dwordx4 v7, s[36:39], 0 offen offset:3072 nt lds
  v_mfma_f32_32x32x16_bf16 v[112:127], v[244:247], a[52:55], v[112:127]
  v_cvt_pk_bf16_f32 v47, v70, v71
  v_rcp_f32 v73, v73
  ds_read_b64_tr_b16 a[126:127], v23 offset:25088
  v_rcp_f32 v74, v74
  v_mfma_f32_16x16x32_bf16 v[32:35], v[44:47], a[128:131], v[28:31]
  v_cvt_pk_bf16_f32 v48, v72, v73
  v_rcp_f32 v75, v75
  v_mfma_f32_32x32x16_bf16 v[112:127], v[248:251], a[56:59], v[112:127]
  v_rcp_f32 v76, v76
  v_cvt_pk_bf16_f32 v49, v74, v75
  v_rcp_f32 v77, v77
  v_rcp_f32 v78, v78
  v_mfma_f32_32x32x16_bf16 v[112:127], v[252:255], a[60:63], v[112:127]
  v_cvt_pk_bf16_f32 v50, v76, v77
  v_rcp_f32 v79, v79
  v_exp_f32 v80, v80
  v_exp_f32 v81, v81
  v_mfma_f32_32x32x16_bf16 v[112:127], v[60:63], a[198:201], v[112:127]
  v_cvt_pk_bf16_f32 v51, v78, v79
  v_exp_f32 v82, v82
  v_exp_f32 v83, v83
  v_exp_f32 v84, v84
  v_mfma_f32_16x16x32_bf16 v[32:35], v[48:51], a[132:135], v[32:35]
  v_exp_f32 v85, v85
  v_exp_f32 v86, v86
  v_exp_f32 v87, v87
  v_exp_f32 v88, v88
  v_exp_f32 v89, v89
  v_exp_f32 v90, v90
  v_exp_f32 v91, v91
  v_exp_f32 v92, v92
  v_exp_f32 v93, v93
  v_exp_f32 v94, v94
  v_exp_f32 v95, v95
  s_waitcnt vmcnt(8)
  ds_read_b128 a[0:3], v8 offset:0
  s_add_u32 m0, s14, 16384
  v_exp_f32 v96, v96
  v_mfma_f32_32x32x16_bf16 v[80:95], a[192:195], a[196:199], v[80:95]
  ds_read_b128 v[0:3], v53 offset:768
  v_exp_f32 v97, v97
  ds_read_b128 a[4:7], v9 offset:0
  v_exp_f32 v98, v98
  ds_read_b128 a[8:11], v10 offset:0
  v_exp_f32 v99, v99
  ds_read_b128 a[12:15], v11 offset:0
  v_exp_f32 v100, v100
  ds_read_b128 a[16:19], v12 offset:0
  v_exp_f32 v101, v101
  ds_read_b128 a[20:23], v13 offset:0
  v_exp_f32 v102, v102
  v_rcp_f32 v80, v80
  v_rcp_f32 v81, v81
  v_rcp_f32 v82, v82
  v_rcp_f32 v83, v83
  v_cvt_pk_bf16_f32 v44, v80, v81
  v_rcp_f32 v84, v84
  s_waitcnt lgkmcnt(6)
  v_mfma_f32_32x32x16_bf16 v[64:79], v[128:131], a[0:3], 0
  v_cvt_pk_bf16_f32 v45, v82, v83
  v_rcp_f32 v85, v85
  v_rcp_f32 v86, v86
  v_rcp_f32 v87, v87
  v_cvt_pk_bf16_f32 v46, v84, v85
  s_waitcnt lgkmcnt(4)
  v_mfma_f32_32x32x16_bf16 v[64:79], v[132:135], a[4:7], v[64:79]
  v_rcp_f32 v88, v88
  v_cvt_pk_bf16_f32 v47, v86, v87
  v_xad_u32 v0, v54, 0, v0
  buffer_load_dwordx4 v0, s[36:39], s52 offen offset:0 nt lds
  v_mfma_f32_16x16x32_bf16 v[32:35], v[44:47], a[136:139], v[32:35]
  v_rcp_f32 v89, v89
  s_waitcnt lgkmcnt(3)
  v_mfma_f32_32x32x16_bf16 v[64:79], v[136:139], a[8:11], v[64:79]
  v_rcp_f32 v90, v90
  v_cvt_pk_bf16_f32 v48, v88, v89
  v_rcp_f32 v91, v91
  v_rcp_f32 v92, v92
  s_waitcnt lgkmcnt(2)
  v_mfma_f32_32x32x16_bf16 v[64:79], v[140:143], a[12:15], v[64:79]
  v_cvt_pk_bf16_f32 v49, v90, v91
  v_rcp_f32 v93, v93
  v_rcp_f32 v94, v94
  v_rcp_f32 v95, v95
  s_waitcnt lgkmcnt(1)
  v_mfma_f32_32x32x16_bf16 v[64:79], v[144:147], a[16:19], v[64:79]
  v_cvt_pk_bf16_f32 v50, v92, v93
  ds_read_b128 a[24:27], v14 offset:0
  v_cvt_pk_bf16_f32 v51, v94, v95
  v_xad_u32 v1, v54, 32, v1
  buffer_load_dwordx4 v1, s[36:39], s53 offen offset:1024 nt lds
  v_mfma_f32_16x16x32_bf16 v[32:35], v[48:51], a[140:143], v[32:35]
  ds_read_b128 a[28:31], v15 offset:0
  v_exp_f32 v103, v103
  s_waitcnt lgkmcnt(2)
  v_mfma_f32_32x32x16_bf16 v[64:79], v[148:151], a[20:23], v[64:79]
  ds_read_b128 v[36:39], v52 offset:4480
  v_exp_f32 v104, v104
  v_exp_f32 v105, v105
  v_exp_f32 v106, v106
  v_mfma_f32_32x32x16_bf16 v[80:95], v[160:163], a[0:3], 0
  v_exp_f32 v107, v107
  v_exp_f32 v108, v108
  v_exp_f32 v109, v109
  v_mfma_f32_32x32x16_bf16 v[80:95], v[164:167], a[4:7], v[80:95]
  v_exp_f32 v110, v110
  v_exp_f32 v111, v111
  ds_read_b64_tr_b16 a[64:65], v16 offset:0
  v_xad_u32 v2, v54, 64, v2
  v_mfma_f32_32x32x16_bf16 v[80:95], v[168:171], a[8:11], v[80:95]
  buffer_load_dwordx4 v2, s[36:39], s54 offen offset:2048 nt lds
  ds_read_b64_tr_b16 a[66:67], v16 offset:512
  ds_read_b64_tr_b16 a[68:69], v17 offset:0
  v_mfma_f32_32x32x16_bf16 v[96:111], a[192:195], a[196:199], v[96:111]
  ds_read_b64_tr_b16 a[70:71], v17 offset:512
  v_xad_u32 v3, v54, s55, v3
  ds_read_b64_tr_b16 a[72:73], v18 offset:0
  ds_read_b64_tr_b16 a[74:75], v18 offset:512
  s_waitcnt lgkmcnt(8)
  v_mfma_f32_32x32x16_bf16 v[64:79], v[152:155], a[24:27], v[64:79]
  v_exp_f32 v112, v112
  v_exp_f32 v113, v113
  buffer_load_dwordx4 v3, s[36:39], 0 offen offset:3072 nt lds
  s_waitcnt lgkmcnt(7)
  v_mfma_f32_32x32x16_bf16 v[64:79], v[156:159], a[28:31], v[64:79]
  v_exp_f32 v114, v114
  v_exp_f32 v115, v115
  v_exp_f32 v116, v116
  v_mfma_f32_32x32x16_bf16 v[64:79], v[60:63], a[196:199], v[64:79]
  v_rcp_f32 v96, v96
  v_rcp_f32 v97, v97
  v_rcp_f32 v98, v98
  v_mfma_f32_32x32x16_bf16 v[80:95], v[172:175], a[12:15], v[80:95]
  v_cvt_pk_bf16_f32 v44, v96, v97
  v_rcp_f32 v99, v99
  v_rcp_f32 v100, v100
  v_rcp_f32 v101, v101
  v_mfma_f32_32x32x16_bf16 v[80:95], v[176:179], a[16:19], v[80:95]
  v_cvt_pk_bf16_f32 v45, v98, v99
  v_rcp_f32 v102, v102
  v_cvt_pk_bf16_f32 v46, v100, v101
  v_rcp_f32 v103, v103
  v_mfma_f32_32x32x16_bf16 v[80:95], v[180:183], a[20:23], v[80:95]
  v_rcp_f32 v104, v104
  v_cvt_pk_bf16_f32 v47, v102, v103
  v_rcp_f32 v105, v105
  v_rcp_f32 v106, v106
  v_mfma_f32_16x16x32_bf16 v[32:35], v[44:47], a[144:147], v[32:35]
  v_cvt_pk_bf16_f32 v48, v104, v105
  v_rcp_f32 v107, v107
  v_mfma_f32_32x32x16_bf16 v[80:95], v[184:187], a[24:27], v[80:95]
  v_rcp_f32 v108, v108
  v_cvt_pk_bf16_f32 v49, v106, v107
  v_rcp_f32 v109, v109
  v_rcp_f32 v110, v110
  v_mfma_f32_32x32x16_bf16 v[80:95], v[188:191], a[28:31], v[80:95]
  v_cvt_pk_bf16_f32 v50, v108, v109
  v_rcp_f32 v111, v111
  v_exp_f32 v117, v117
  v_exp_f32 v118, v118
  v_mfma_f32_32x32x16_bf16 v[80:95], v[60:63], a[200:203], v[80:95]
  v_cvt_pk_bf16_f32 v51, v110, v111
  v_exp_f32 v119, v119
  v_exp_f32 v120, v120
  v_exp_f32 v121, v121
  v_mfma_f32_16x16x32_bf16 v[32:35], v[48:51], a[148:151], v[32:35]
  v_exp_f32 v122, v122
  v_mfma_f32_32x32x16_bf16 v[96:111], v[192:195], a[0:3], 0
  v_exp_f32 v123, v123
  v_exp_f32 v124, v124
  v_exp_f32 v125, v125
  v_mfma_f32_32x32x16_bf16 v[96:111], v[196:199], a[4:7], v[96:111]
  v_exp_f32 v126, v126
  v_exp_f32 v127, v127
  ds_read_b64_tr_b16 a[76:77], v19 offset:0
  ds_read_b128 v[4:7], v53 offset:784
  v_mfma_f32_32x32x16_bf16 v[96:111], v[200:203], a[8:11], v[96:111]
  ds_read_b64_tr_b16 a[78:79], v19 offset:512
  ds_read_b64_tr_b16 a[80:81], v20 offset:0
  ds_read_b64_tr_b16 a[82:83], v20 offset:512
  s_add_u32 m0, s14, 20480
  v_mfma_f32_32x32x16_bf16 v[112:127], a[192:195], a[196:199], v[112:127]
  ds_read_b64_tr_b16 a[84:85], v21 offset:0
  v_exp_f32 v64, v64
  v_exp_f32 v65, v65
  v_exp_f32 v66, v66
  v_mfma_f32_32x32x16_bf16 v[96:111], v[204:207], a[12:15], v[96:111]
  v_exp_f32 v67, v67
  v_exp_f32 v68, v68
  v_exp_f32 v69, v69
  v_mfma_f32_32x32x16_bf16 v[96:111], v[208:211], a[16:19], v[96:111]
  v_exp_f32 v70, v70
  v_exp_f32 v71, v71
  v_exp_f32 v72, v72
  v_mfma_f32_32x32x16_bf16 v[96:111], v[212:215], a[20:23], v[96:111]
  v_rcp_f32 v112, v112
  v_rcp_f32 v113, v113
  v_rcp_f32 v114, v114
  v_mfma_f32_32x32x16_bf16 v[96:111], v[216:219], a[24:27], v[96:111]
  v_cvt_pk_bf16_f32 v44, v112, v113
  v_rcp_f32 v115, v115
  v_rcp_f32 v116, v116
  v_rcp_f32 v117, v117
  v_mfma_f32_32x32x16_bf16 v[96:111], v[220:223], a[28:31], v[96:111]
  v_cvt_pk_bf16_f32 v45, v114, v115
  v_rcp_f32 v118, v118
  v_cvt_pk_bf16_f32 v46, v116, v117
  v_rcp_f32 v119, v119
  v_mfma_f32_32x32x16_bf16 v[96:111], v[60:63], a[194:197], v[96:111]
  v_rcp_f32 v120, v120
  v_cvt_pk_bf16_f32 v47, v118, v119
  s_waitcnt lgkmcnt(4)
  v_xad_u32 v4, v54, s72, v4
  buffer_load_dwordx4 v4, s[36:39], s52 offen offset:0 nt lds
  v_mfma_f32_16x16x32_bf16 v[32:35], v[44:47], a[152:155], v[32:35]
  v_rcp_f32 v121, v121
  v_rcp_f32 v122, v122
  v_rcp_f32 v123, v123
  v_cvt_pk_bf16_f32 v48, v120, v121
  v_rcp_f32 v124, v124
  v_rcp_f32 v125, v125
  v_cvt_pk_bf16_f32 v49, v122, v123
  v_rcp_f32 v126, v126
  v_rcp_f32 v127, v127
  v_cvt_pk_bf16_f32 v50, v124, v125
  v_xad_u32 v5, v54, s73, v5
  buffer_load_dwordx4 v5, s[36:39], s53 offen offset:1024 nt lds
  v_cvt_pk_bf16_f32 v51, v126, v127
  v_mfma_f32_32x32x16_bf16 v[112:127], v[224:227], a[0:3], 0
  v_exp_f32 v73, v73
  v_exp_f32 v74, v74
  v_exp_f32 v75, v75
  v_mfma_f32_16x16x32_bf16 v[32:35], v[48:51], a[156:159], v[32:35]
  v_exp_f32 v76, v76
  v_mfma_f32_32x32x16_bf16 v[112:127], v[228:231], a[4:7], v[112:127]
  v_exp_f32 v77, v77
  v_exp_f32 v78, v78
  v_exp_f32 v79, v79
  v_mfma_f32_32x32x16_bf16 v[112:127], v[232:235], a[8:11], v[112:127]
  ds_read_b64_tr_b16 a[86:87], v21 offset:512
  v_xad_u32 v6, v54, s74, v6
  v_mul_legacy_f32 v32, v32, v36
  v_mul_legacy_f32 v33, v33, v37
  v_mul_legacy_f32 v34, v34, v38
  v_mfma_f32_32x32x16_bf16 v[64:79], a[192:195], a[196:199], v[64:79]
  v_mul_legacy_f32 v35, v35, v39
  v_cvt_pk_bf16_f32 v40, v32, v33
  v_cvt_pk_bf16_f32 v41, v34, v35
  buffer_load_dwordx4 v6, s[36:39], s54 offen offset:2048 nt lds
  v_mfma_f32_32x32x16_bf16 v[112:127], v[236:239], a[12:15], v[112:127]
  v_mov_b32_dpp v42, v40 quad_perm:[1,0,3,2] row_mask:0xf bank_mask:0xf
  v_mov_b32_dpp v43, v41 quad_perm:[1,0,3,2] row_mask:0xf bank_mask:0xf
  ds_read_b64_tr_b16 a[88:89], v22 offset:0
  ds_read_b64_tr_b16 a[90:91], v22 offset:512
  v_mfma_f32_16x16x32_bf16 a[160:163], v[40:43], a[96:99], a[160:163]
  ds_read_b64_tr_b16 a[92:93], v23 offset:0
  v_xad_u32 v7, v54, s11, v7
  v_mfma_f32_16x16x32_bf16 a[176:179], v[40:43], a[112:115], a[176:179]
  v_rcp_f32 v64, v64
  v_mfma_f32_16x16x32_bf16 a[164:167], v[40:43], a[100:103], a[164:167]
  v_rcp_f32 v65, v65
  v_mfma_f32_16x16x32_bf16 a[180:183], v[40:43], a[116:119], a[180:183]
  v_rcp_f32 v66, v66
  v_mfma_f32_16x16x32_bf16 a[168:171], v[40:43], a[104:107], a[168:171]
  v_cvt_pk_bf16_f32 v44, v64, v65
  v_rcp_f32 v67, v67
  v_mfma_f32_16x16x32_bf16 a[184:187], v[40:43], a[120:123], a[184:187]
  v_rcp_f32 v68, v68
  v_mfma_f32_16x16x32_bf16 a[172:175], v[40:43], a[108:111], a[172:175]
  v_cvt_pk_bf16_f32 v45, v66, v67
  v_rcp_f32 v69, v69
  v_mfma_f32_16x16x32_bf16 a[188:191], v[40:43], a[124:127], a[188:191]
  v_rcp_f32 v70, v70
  v_mfma_f32_32x32x16_bf16 v[112:127], v[240:243], a[16:19], v[112:127]
  v_cvt_pk_bf16_f32 v46, v68, v69
  v_rcp_f32 v71, v71
  v_rcp_f32 v72, v72
  buffer_load_dwordx4 v7, s[36:39], 0 offen offset:3072 nt lds
  v_mfma_f32_32x32x16_bf16 v[112:127], v[244:247], a[20:23], v[112:127]
  v_cvt_pk_bf16_f32 v47, v70, v71
  v_rcp_f32 v73, v73
  ds_read_b64_tr_b16 a[94:95], v23 offset:512
  v_rcp_f32 v74, v74
  v_mfma_f32_16x16x32_bf16 v[32:35], v[44:47], a[128:131], v[28:31]
  v_cvt_pk_bf16_f32 v48, v72, v73
  v_rcp_f32 v75, v75
  v_mfma_f32_32x32x16_bf16 v[112:127], v[248:251], a[24:27], v[112:127]
  v_rcp_f32 v76, v76
  v_cvt_pk_bf16_f32 v49, v74, v75
  v_rcp_f32 v77, v77
  v_rcp_f32 v78, v78
  v_mfma_f32_32x32x16_bf16 v[112:127], v[252:255], a[28:31], v[112:127]
  v_cvt_pk_bf16_f32 v50, v76, v77
  v_rcp_f32 v79, v79
  v_exp_f32 v80, v80
  v_exp_f32 v81, v81
  v_mfma_f32_32x32x16_bf16 v[112:127], v[60:63], a[198:201], v[112:127]
  v_cvt_pk_bf16_f32 v51, v78, v79
  v_exp_f32 v82, v82
  v_exp_f32 v83, v83
  v_exp_f32 v84, v84
  v_mfma_f32_16x16x32_bf16 v[32:35], v[48:51], a[132:135], v[32:35]
  v_exp_f32 v85, v85
  v_exp_f32 v86, v86
  v_exp_f32 v87, v87
  v_exp_f32 v88, v88
  v_exp_f32 v89, v89
  v_exp_f32 v90, v90
  v_exp_f32 v91, v91
  v_exp_f32 v92, v92
  v_exp_f32 v93, v93
  v_exp_f32 v94, v94
  v_exp_f32 v95, v95
  s_waitcnt vmcnt(8)
  ds_read_b128 a[32:35], v8 offset:8192
  v_exp_f32 v96, v96
  ds_read_b128 a[36:39], v9 offset:8192
  v_mfma_f32_32x32x16_bf16 v[80:95], a[192:195], a[196:199], v[80:95]
  ds_read_b128 a[40:43], v10 offset:8192
  v_exp_f32 v97, v97
  ds_read_b128 a[44:47], v11 offset:8192
  v_exp_f32 v98, v98
  ds_read_b128 a[48:51], v12 offset:8192
  v_exp_f32 v99, v99
  ds_read_b128 a[52:55], v13 offset:8192
  v_exp_f32 v100, v100
  ds_read_b128 a[56:59], v14 offset:8192
  v_exp_f32 v101, v101
  ds_read_b128 a[60:63], v15 offset:8192
  v_exp_f32 v102, v102
  v_rcp_f32 v80, v80
  v_rcp_f32 v81, v81
  v_rcp_f32 v82, v82
  v_rcp_f32 v83, v83
  v_cvt_pk_bf16_f32 v44, v80, v81
  v_rcp_f32 v84, v84
  s_waitcnt lgkmcnt(7)
  v_mfma_f32_32x32x16_bf16 v[64:79], v[128:131], a[32:35], 0
  v_cvt_pk_bf16_f32 v45, v82, v83
  v_rcp_f32 v85, v85
  v_rcp_f32 v86, v86
  v_rcp_f32 v87, v87
  s_waitcnt lgkmcnt(6)
  v_mfma_f32_32x32x16_bf16 v[64:79], v[132:135], a[36:39], v[64:79]
  v_cvt_pk_bf16_f32 v46, v84, v85
  v_rcp_f32 v88, v88
  v_cvt_pk_bf16_f32 v47, v86, v87
  v_rcp_f32 v89, v89
  s_waitcnt lgkmcnt(5)
  v_mfma_f32_32x32x16_bf16 v[64:79], v[136:139], a[40:43], v[64:79]
  v_rcp_f32 v90, v90
  v_cvt_pk_bf16_f32 v48, v88, v89
  v_rcp_f32 v91, v91
  v_rcp_f32 v92, v92
  v_mfma_f32_16x16x32_bf16 v[32:35], v[44:47], a[136:139], v[32:35]
  v_cvt_pk_bf16_f32 v49, v90, v91
  v_rcp_f32 v93, v93
  s_waitcnt lgkmcnt(4)
  v_mfma_f32_32x32x16_bf16 v[64:79], v[140:143], a[44:47], v[64:79]
  v_rcp_f32 v94, v94
  v_cvt_pk_bf16_f32 v50, v92, v93
  v_rcp_f32 v95, v95
  ds_read_b128 v[36:39], v52 offset:4608
  s_waitcnt lgkmcnt(4)
  v_mfma_f32_32x32x16_bf16 v[64:79], v[144:147], a[48:51], v[64:79]
  v_cvt_pk_bf16_f32 v51, v94, v95
  v_exp_f32 v103, v103
  v_exp_f32 v104, v104
  v_exp_f32 v105, v105
  v_mfma_f32_16x16x32_bf16 v[32:35], v[48:51], a[140:143], v[32:35]
  v_exp_f32 v106, v106
  s_waitcnt lgkmcnt(3)
  v_mfma_f32_32x32x16_bf16 v[64:79], v[148:151], a[52:55], v[64:79]
  v_exp_f32 v107, v107
  v_exp_f32 v108, v108
  v_exp_f32 v109, v109
  s_waitcnt lgkmcnt(2)
  v_mfma_f32_32x32x16_bf16 v[64:79], v[152:155], a[56:59], v[64:79]
  v_exp_f32 v110, v110
  v_exp_f32 v111, v111
  ds_read_b64_tr_b16 a[96:97], v16 offset:8192
  ds_read_b64_tr_b16 a[98:99], v16 offset:8704
  s_waitcnt lgkmcnt(3)
  v_mfma_f32_32x32x16_bf16 v[64:79], v[156:159], a[60:63], v[64:79]
  ds_read_b64_tr_b16 a[100:101], v17 offset:8192
  ds_read_b64_tr_b16 a[102:103], v17 offset:8704
  ds_read_b64_tr_b16 a[104:105], v18 offset:8192
  ds_read_b64_tr_b16 a[106:107], v18 offset:8704
  v_mfma_f32_32x32x16_bf16 v[96:111], a[192:195], a[196:199], v[96:111]
  v_exp_f32 v112, v112
  v_exp_f32 v113, v113
  v_exp_f32 v114, v114
  v_mfma_f32_32x32x16_bf16 v[64:79], v[60:63], a[196:199], v[64:79]
  v_exp_f32 v115, v115
  v_exp_f32 v116, v116
  v_exp_f32 v117, v117
  v_mfma_f32_32x32x16_bf16 v[80:95], v[160:163], a[32:35], 0
  v_exp_f32 v118, v118
  v_exp_f32 v119, v119
  v_exp_f32 v120, v120
  v_mfma_f32_32x32x16_bf16 v[80:95], v[164:167], a[36:39], v[80:95]
  v_rcp_f32 v96, v96
  v_rcp_f32 v97, v97
  v_rcp_f32 v98, v98
  v_mfma_f32_32x32x16_bf16 v[80:95], v[168:171], a[40:43], v[80:95]
  v_cvt_pk_bf16_f32 v44, v96, v97
  v_rcp_f32 v99, v99
  v_rcp_f32 v100, v100
  v_rcp_f32 v101, v101
  v_mfma_f32_32x32x16_bf16 v[80:95], v[172:175], a[44:47], v[80:95]
  v_cvt_pk_bf16_f32 v45, v98, v99
  v_rcp_f32 v102, v102
  v_cvt_pk_bf16_f32 v46, v100, v101
  v_rcp_f32 v103, v103
  v_mfma_f32_32x32x16_bf16 v[80:95], v[176:179], a[48:51], v[80:95]
  v_rcp_f32 v104, v104
  v_cvt_pk_bf16_f32 v47, v102, v103
  v_rcp_f32 v105, v105
  v_rcp_f32 v106, v106
  v_mfma_f32_16x16x32_bf16 v[32:35], v[44:47], a[144:147], v[32:35]
  v_cvt_pk_bf16_f32 v48, v104, v105
  v_rcp_f32 v107, v107
  v_mfma_f32_32x32x16_bf16 v[80:95], v[180:183], a[52:55], v[80:95]
  v_rcp_f32 v108, v108
  v_cvt_pk_bf16_f32 v49, v106, v107
  v_rcp_f32 v109, v109
  v_rcp_f32 v110, v110
  v_mfma_f32_32x32x16_bf16 v[80:95], v[184:187], a[56:59], v[80:95]
  v_cvt_pk_bf16_f32 v50, v108, v109
  v_rcp_f32 v111, v111
  v_exp_f32 v121, v121
  v_exp_f32 v122, v122
  v_mfma_f32_32x32x16_bf16 v[80:95], v[188:191], a[60:63], v[80:95]
  v_cvt_pk_bf16_f32 v51, v110, v111
  v_exp_f32 v123, v123
  v_exp_f32 v124, v124
  v_exp_f32 v125, v125
  v_mfma_f32_16x16x32_bf16 v[32:35], v[48:51], a[148:151], v[32:35]
  v_exp_f32 v126, v126
  v_mfma_f32_32x32x16_bf16 v[80:95], v[60:63], a[200:203], v[80:95]
  v_exp_f32 v127, v127
  ds_read_b64_tr_b16 a[108:109], v19 offset:8192
  ds_read_b64_tr_b16 a[110:111], v19 offset:8704
  ds_read_b64_tr_b16 a[112:113], v20 offset:8192
  v_mfma_f32_32x32x16_bf16 v[112:127], a[192:195], a[196:199], v[112:127]
  ds_read_b64_tr_b16 a[114:115], v20 offset:8704
  ds_read_b64_tr_b16 a[116:117], v21 offset:8192
  v_exp_f32 v64, v64
  v_exp_f32 v65, v65
  v_mfma_f32_32x32x16_bf16 v[96:111], v[192:195], a[32:35], 0
  v_exp_f32 v66, v66
  v_exp_f32 v67, v67
  v_exp_f32 v68, v68
  v_mfma_f32_32x32x16_bf16 v[96:111], v[196:199], a[36:39], v[96:111]
  v_exp_f32 v69, v69
  v_exp_f32 v70, v70
  v_exp_f32 v71, v71
  v_mfma_f32_32x32x16_bf16 v[96:111], v[200:203], a[40:43], v[96:111]
  v_rcp_f32 v112, v112
  v_rcp_f32 v113, v113
  v_rcp_f32 v114, v114
  v_mfma_f32_32x32x16_bf16 v[96:111], v[204:207], a[44:47], v[96:111]
  v_cvt_pk_bf16_f32 v44, v112, v113
  v_rcp_f32 v115, v115
  v_rcp_f32 v116, v116
  v_rcp_f32 v117, v117
  v_mfma_f32_32x32x16_bf16 v[96:111], v[208:211], a[48:51], v[96:111]
  v_cvt_pk_bf16_f32 v45, v114, v115
  v_rcp_f32 v118, v118
  v_cvt_pk_bf16_f32 v46, v116, v117
  v_rcp_f32 v119, v119
  v_mfma_f32_32x32x16_bf16 v[96:111], v[212:215], a[52:55], v[96:111]
  v_rcp_f32 v120, v120
  v_cvt_pk_bf16_f32 v47, v118, v119
  v_rcp_f32 v121, v121
  v_rcp_f32 v122, v122
  v_mfma_f32_16x16x32_bf16 v[32:35], v[44:47], a[152:155], v[32:35]
  v_cvt_pk_bf16_f32 v48, v120, v121
  v_rcp_f32 v123, v123
  v_mfma_f32_32x32x16_bf16 v[96:111], v[216:219], a[56:59], v[96:111]
  v_rcp_f32 v124, v124
  v_cvt_pk_bf16_f32 v49, v122, v123
  v_rcp_f32 v125, v125
  v_rcp_f32 v126, v126
  v_mfma_f32_32x32x16_bf16 v[96:111], v[220:223], a[60:63], v[96:111]
  v_cvt_pk_bf16_f32 v50, v124, v125
  v_rcp_f32 v127, v127
  v_exp_f32 v72, v72
  v_exp_f32 v73, v73
  v_mfma_f32_32x32x16_bf16 v[96:111], v[60:63], a[194:197], v[96:111]
  v_cvt_pk_bf16_f32 v51, v126, v127
  v_exp_f32 v74, v74
  v_exp_f32 v75, v75
  v_exp_f32 v76, v76
  v_mfma_f32_16x16x32_bf16 v[32:35], v[48:51], a[156:159], v[32:35]
  v_exp_f32 v77, v77
  v_mfma_f32_32x32x16_bf16 v[112:127], v[224:227], a[32:35], 0
  v_exp_f32 v78, v78
  v_exp_f32 v79, v79
  ds_read_b64_tr_b16 a[118:119], v21 offset:8704
  ds_read_b64_tr_b16 a[120:121], v22 offset:8192
  v_mfma_f32_32x32x16_bf16 v[112:127], v[228:231], a[36:39], v[112:127]
  ds_read_b64_tr_b16 a[122:123], v22 offset:8704
  s_waitcnt lgkmcnt(14)
  v_mul_legacy_f32 v32, v32, v36
  v_mul_legacy_f32 v33, v33, v37
  v_mul_legacy_f32 v34, v34, v38
  v_mul_legacy_f32 v35, v35, v39
  v_cvt_pk_bf16_f32 v40, v32, v33
  v_mfma_f32_32x32x16_bf16 v[64:79], a[192:195], a[196:199], v[64:79]
  v_cvt_pk_bf16_f32 v41, v34, v35
  v_mov_b32_dpp v42, v40 quad_perm:[1,0,3,2] row_mask:0xf bank_mask:0xf
  ds_read_b64_tr_b16 a[124:125], v23 offset:8192
  v_mov_b32_dpp v43, v41 quad_perm:[1,0,3,2] row_mask:0xf bank_mask:0xf
  ds_read_b64_tr_b16 a[126:127], v23 offset:8704
  v_mfma_f32_32x32x16_bf16 v[112:127], v[232:235], a[40:43], v[112:127]
  v_exp_f32 v80, v80
  v_exp_f32 v81, v81
  v_exp_f32 v82, v82
  v_mfma_f32_16x16x32_bf16 a[160:163], v[40:43], a[64:67], a[160:163]
  v_exp_f32 v83, v83
  v_mfma_f32_16x16x32_bf16 a[176:179], v[40:43], a[80:83], a[176:179]
  v_rcp_f32 v64, v64
  v_mfma_f32_16x16x32_bf16 a[164:167], v[40:43], a[68:71], a[164:167]
  v_rcp_f32 v65, v65
  v_mfma_f32_16x16x32_bf16 a[180:183], v[40:43], a[84:87], a[180:183]
  v_rcp_f32 v66, v66
  v_mfma_f32_16x16x32_bf16 a[168:171], v[40:43], a[72:75], a[168:171]
  v_cvt_pk_bf16_f32 v44, v64, v65
  v_rcp_f32 v67, v67
  v_mfma_f32_16x16x32_bf16 a[184:187], v[40:43], a[88:91], a[184:187]
  v_rcp_f32 v68, v68
  v_mfma_f32_16x16x32_bf16 a[172:175], v[40:43], a[76:79], a[172:175]
  v_cvt_pk_bf16_f32 v45, v66, v67
  v_rcp_f32 v69, v69
  v_mfma_f32_16x16x32_bf16 a[188:191], v[40:43], a[92:95], a[188:191]
  v_rcp_f32 v70, v70
  v_mfma_f32_32x32x16_bf16 v[112:127], v[236:239], a[44:47], v[112:127]
  v_cvt_pk_bf16_f32 v46, v68, v69
  v_rcp_f32 v71, v71
  v_rcp_f32 v72, v72
  v_rcp_f32 v73, v73
  v_mfma_f32_32x32x16_bf16 v[112:127], v[240:243], a[48:51], v[112:127]
  v_cvt_pk_bf16_f32 v47, v70, v71
  v_rcp_f32 v74, v74
  v_cvt_pk_bf16_f32 v48, v72, v73
  v_rcp_f32 v75, v75
  v_mfma_f32_16x16x32_bf16 v[32:35], v[44:47], a[128:131], v[28:31]
  v_rcp_f32 v76, v76
  v_mfma_f32_32x32x16_bf16 v[112:127], v[244:247], a[52:55], v[112:127]
  v_cvt_pk_bf16_f32 v49, v74, v75
  v_rcp_f32 v77, v77
  v_rcp_f32 v78, v78
  v_rcp_f32 v79, v79
  v_mfma_f32_32x32x16_bf16 v[112:127], v[248:251], a[56:59], v[112:127]
  v_cvt_pk_bf16_f32 v50, v76, v77
  v_exp_f32 v84, v84
  v_cvt_pk_bf16_f32 v51, v78, v79
  v_exp_f32 v85, v85
  v_mfma_f32_32x32x16_bf16 v[112:127], v[252:255], a[60:63], v[112:127]
  v_exp_f32 v86, v86
  v_exp_f32 v87, v87
  v_exp_f32 v88, v88
  v_mfma_f32_16x16x32_bf16 v[32:35], v[48:51], a[132:135], v[32:35]
  v_exp_f32 v89, v89
  v_mfma_f32_32x32x16_bf16 v[112:127], v[60:63], a[198:201], v[112:127]
  v_exp_f32 v90, v90
  v_exp_f32 v91, v91
  v_exp_f32 v92, v92
  v_exp_f32 v93, v93
  v_exp_f32 v94, v94
  v_exp_f32 v95, v95
  s_waitcnt vmcnt(0)
  ds_read_b128 a[0:3], v8 offset:16384
  v_exp_f32 v96, v96
  ds_read_b128 a[4:7], v9 offset:16384
  v_mfma_f32_32x32x16_bf16 v[80:95], a[192:195], a[196:199], v[80:95]
  ds_read_b128 a[8:11], v10 offset:16384
  v_exp_f32 v97, v97
  ds_read_b128 a[12:15], v11 offset:16384
  v_exp_f32 v98, v98
  ds_read_b128 a[16:19], v12 offset:16384
  v_exp_f32 v99, v99
  ds_read_b128 a[20:23], v13 offset:16384
  v_exp_f32 v100, v100
  ds_read_b128 a[24:27], v14 offset:16384
  v_exp_f32 v101, v101
  ds_read_b128 a[28:31], v15 offset:16384
  v_exp_f32 v102, v102
  v_rcp_f32 v80, v80
  v_rcp_f32 v81, v81
  v_rcp_f32 v82, v82
  v_rcp_f32 v83, v83
  v_cvt_pk_bf16_f32 v44, v80, v81
  v_rcp_f32 v84, v84
  s_waitcnt lgkmcnt(7)
  v_mfma_f32_32x32x16_bf16 v[64:79], v[128:131], a[0:3], 0
  v_cvt_pk_bf16_f32 v45, v82, v83
  v_rcp_f32 v85, v85
  v_rcp_f32 v86, v86
  v_rcp_f32 v87, v87
  s_waitcnt lgkmcnt(6)
  v_mfma_f32_32x32x16_bf16 v[64:79], v[132:135], a[4:7], v[64:79]
  v_cvt_pk_bf16_f32 v46, v84, v85
  v_rcp_f32 v88, v88
  v_cvt_pk_bf16_f32 v47, v86, v87
  v_rcp_f32 v89, v89
  s_waitcnt lgkmcnt(5)
  v_mfma_f32_32x32x16_bf16 v[64:79], v[136:139], a[8:11], v[64:79]
  v_rcp_f32 v90, v90
  v_cvt_pk_bf16_f32 v48, v88, v89
  v_rcp_f32 v91, v91
  v_rcp_f32 v92, v92
  v_mfma_f32_16x16x32_bf16 v[32:35], v[44:47], a[136:139], v[32:35]
  v_cvt_pk_bf16_f32 v49, v90, v91
  v_rcp_f32 v93, v93
  s_waitcnt lgkmcnt(4)
  v_mfma_f32_32x32x16_bf16 v[64:79], v[140:143], a[12:15], v[64:79]
  v_rcp_f32 v94, v94
  v_cvt_pk_bf16_f32 v50, v92, v93
  v_rcp_f32 v95, v95
  ds_read_b128 v[36:39], v52 offset:4736
  s_waitcnt lgkmcnt(4)
  v_mfma_f32_32x32x16_bf16 v[64:79], v[144:147], a[16:19], v[64:79]
  v_cvt_pk_bf16_f32 v51, v94, v95
  v_exp_f32 v103, v103
  v_exp_f32 v104, v104
  v_exp_f32 v105, v105
  v_mfma_f32_16x16x32_bf16 v[32:35], v[48:51], a[140:143], v[32:35]
  v_exp_f32 v106, v106
  s_waitcnt lgkmcnt(3)
  v_mfma_f32_32x32x16_bf16 v[64:79], v[148:151], a[20:23], v[64:79]
  v_exp_f32 v107, v107
  v_exp_f32 v108, v108
  v_exp_f32 v109, v109
  s_waitcnt lgkmcnt(2)
  v_mfma_f32_32x32x16_bf16 v[64:79], v[152:155], a[24:27], v[64:79]
  v_exp_f32 v110, v110
  v_exp_f32 v111, v111
  ds_read_b64_tr_b16 a[64:65], v16 offset:16384
  ds_read_b64_tr_b16 a[66:67], v16 offset:16896
  s_waitcnt lgkmcnt(3)
  v_mfma_f32_32x32x16_bf16 v[64:79], v[156:159], a[28:31], v[64:79]
  ds_read_b64_tr_b16 a[68:69], v17 offset:16384
  ds_read_b64_tr_b16 a[70:71], v17 offset:16896
  ds_read_b64_tr_b16 a[72:73], v18 offset:16384
  ds_read_b64_tr_b16 a[74:75], v18 offset:16896
  v_mfma_f32_32x32x16_bf16 v[96:111], a[192:195], a[196:199], v[96:111]
  v_exp_f32 v112, v112
  v_exp_f32 v113, v113
  v_exp_f32 v114, v114
  v_mfma_f32_32x32x16_bf16 v[64:79], v[60:63], a[196:199], v[64:79]
  v_exp_f32 v115, v115
  v_exp_f32 v116, v116
  v_exp_f32 v117, v117
  v_mfma_f32_32x32x16_bf16 v[80:95], v[160:163], a[0:3], 0
  v_exp_f32 v118, v118
  v_exp_f32 v119, v119
  v_exp_f32 v120, v120
  v_mfma_f32_32x32x16_bf16 v[80:95], v[164:167], a[4:7], v[80:95]
  v_rcp_f32 v96, v96
  v_rcp_f32 v97, v97
  v_rcp_f32 v98, v98
  v_mfma_f32_32x32x16_bf16 v[80:95], v[168:171], a[8:11], v[80:95]
  v_cvt_pk_bf16_f32 v44, v96, v97
  v_rcp_f32 v99, v99
  v_rcp_f32 v100, v100
  v_rcp_f32 v101, v101
  v_mfma_f32_32x32x16_bf16 v[80:95], v[172:175], a[12:15], v[80:95]
  v_cvt_pk_bf16_f32 v45, v98, v99
  v_rcp_f32 v102, v102
  v_cvt_pk_bf16_f32 v46, v100, v101
  v_rcp_f32 v103, v103
  v_mfma_f32_32x32x16_bf16 v[80:95], v[176:179], a[16:19], v[80:95]
  v_rcp_f32 v104, v104
  v_cvt_pk_bf16_f32 v47, v102, v103
  v_rcp_f32 v105, v105
  v_rcp_f32 v106, v106
  v_mfma_f32_16x16x32_bf16 v[32:35], v[44:47], a[144:147], v[32:35]
  v_cvt_pk_bf16_f32 v48, v104, v105
  v_rcp_f32 v107, v107
  v_mfma_f32_32x32x16_bf16 v[80:95], v[180:183], a[20:23], v[80:95]
  v_rcp_f32 v108, v108
  v_cvt_pk_bf16_f32 v49, v106, v107
  v_rcp_f32 v109, v109
  v_rcp_f32 v110, v110
  v_mfma_f32_32x32x16_bf16 v[80:95], v[184:187], a[24:27], v[80:95]
  v_cvt_pk_bf16_f32 v50, v108, v109
  v_rcp_f32 v111, v111
  v_exp_f32 v121, v121
  v_exp_f32 v122, v122
  v_mfma_f32_32x32x16_bf16 v[80:95], v[188:191], a[28:31], v[80:95]
  v_cvt_pk_bf16_f32 v51, v110, v111
  v_exp_f32 v123, v123
  v_exp_f32 v124, v124
  v_exp_f32 v125, v125
  v_mfma_f32_16x16x32_bf16 v[32:35], v[48:51], a[148:151], v[32:35]
  v_exp_f32 v126, v126
  v_mfma_f32_32x32x16_bf16 v[80:95], v[60:63], a[200:203], v[80:95]
  v_exp_f32 v127, v127
  ds_read_b64_tr_b16 a[76:77], v19 offset:16384
  ds_read_b64_tr_b16 a[78:79], v19 offset:16896
  ds_read_b64_tr_b16 a[80:81], v20 offset:16384
  v_mfma_f32_32x32x16_bf16 v[112:127], a[192:195], a[196:199], v[112:127]
  ds_read_b64_tr_b16 a[82:83], v20 offset:16896
  ds_read_b64_tr_b16 a[84:85], v21 offset:16384
  v_exp_f32 v64, v64
  v_exp_f32 v65, v65
  v_mfma_f32_32x32x16_bf16 v[96:111], v[192:195], a[0:3], 0
  v_exp_f32 v66, v66
  v_exp_f32 v67, v67
  v_exp_f32 v68, v68
  v_mfma_f32_32x32x16_bf16 v[96:111], v[196:199], a[4:7], v[96:111]
  v_exp_f32 v69, v69
  v_exp_f32 v70, v70
  v_exp_f32 v71, v71
  v_mfma_f32_32x32x16_bf16 v[96:111], v[200:203], a[8:11], v[96:111]
  v_rcp_f32 v112, v112
  v_rcp_f32 v113, v113
  v_rcp_f32 v114, v114
  v_mfma_f32_32x32x16_bf16 v[96:111], v[204:207], a[12:15], v[96:111]
  v_cvt_pk_bf16_f32 v44, v112, v113
  v_rcp_f32 v115, v115
  v_rcp_f32 v116, v116
  v_rcp_f32 v117, v117
  v_mfma_f32_32x32x16_bf16 v[96:111], v[208:211], a[16:19], v[96:111]
  v_cvt_pk_bf16_f32 v45, v114, v115
  v_rcp_f32 v118, v118
  v_cvt_pk_bf16_f32 v46, v116, v117
  v_rcp_f32 v119, v119
  v_mfma_f32_32x32x16_bf16 v[96:111], v[212:215], a[20:23], v[96:111]
  v_rcp_f32 v120, v120
  v_cvt_pk_bf16_f32 v47, v118, v119
  v_rcp_f32 v121, v121
  v_rcp_f32 v122, v122
  v_mfma_f32_16x16x32_bf16 v[32:35], v[44:47], a[152:155], v[32:35]
  v_cvt_pk_bf16_f32 v48, v120, v121
  v_rcp_f32 v123, v123
  v_mfma_f32_32x32x16_bf16 v[96:111], v[216:219], a[24:27], v[96:111]
  v_rcp_f32 v124, v124
  v_cvt_pk_bf16_f32 v49, v122, v123
  v_rcp_f32 v125, v125
  v_rcp_f32 v126, v126
  v_mfma_f32_32x32x16_bf16 v[96:111], v[220:223], a[28:31], v[96:111]
  v_cvt_pk_bf16_f32 v50, v124, v125
  v_rcp_f32 v127, v127
  v_exp_f32 v72, v72
  v_exp_f32 v73, v73
  v_mfma_f32_32x32x16_bf16 v[96:111], v[60:63], a[194:197], v[96:111]
  v_cvt_pk_bf16_f32 v51, v126, v127
  v_exp_f32 v74, v74
  v_exp_f32 v75, v75
  v_exp_f32 v76, v76
  v_mfma_f32_16x16x32_bf16 v[32:35], v[48:51], a[156:159], v[32:35]
  v_exp_f32 v77, v77
  v_mfma_f32_32x32x16_bf16 v[112:127], v[224:227], a[0:3], 0
  v_exp_f32 v78, v78
  v_exp_f32 v79, v79
  ds_read_b64_tr_b16 a[86:87], v21 offset:16896
  ds_read_b64_tr_b16 a[88:89], v22 offset:16384
  v_mfma_f32_32x32x16_bf16 v[112:127], v[228:231], a[4:7], v[112:127]
  ds_read_b64_tr_b16 a[90:91], v22 offset:16896
  s_waitcnt lgkmcnt(14)
  v_mul_legacy_f32 v32, v32, v36
  v_mul_legacy_f32 v33, v33, v37
  v_mul_legacy_f32 v34, v34, v38
  v_mul_legacy_f32 v35, v35, v39
  v_cvt_pk_bf16_f32 v40, v32, v33
  v_mfma_f32_32x32x16_bf16 v[64:79], a[192:195], a[196:199], v[64:79]
  v_cvt_pk_bf16_f32 v41, v34, v35
  v_mov_b32_dpp v42, v40 quad_perm:[1,0,3,2] row_mask:0xf bank_mask:0xf
  ds_read_b64_tr_b16 a[92:93], v23 offset:16384
  v_mov_b32_dpp v43, v41 quad_perm:[1,0,3,2] row_mask:0xf bank_mask:0xf
  ds_read_b64_tr_b16 a[94:95], v23 offset:16896
  v_mfma_f32_32x32x16_bf16 v[112:127], v[232:235], a[8:11], v[112:127]
  v_exp_f32 v80, v80
  v_exp_f32 v81, v81
  v_exp_f32 v82, v82
  v_mfma_f32_16x16x32_bf16 a[160:163], v[40:43], a[96:99], a[160:163]
  v_exp_f32 v83, v83
  v_mfma_f32_16x16x32_bf16 a[176:179], v[40:43], a[112:115], a[176:179]
  v_rcp_f32 v64, v64
  v_mfma_f32_16x16x32_bf16 a[164:167], v[40:43], a[100:103], a[164:167]
  v_rcp_f32 v65, v65
  v_mfma_f32_16x16x32_bf16 a[180:183], v[40:43], a[116:119], a[180:183]
  v_rcp_f32 v66, v66
  v_mfma_f32_16x16x32_bf16 a[168:171], v[40:43], a[104:107], a[168:171]
  v_cvt_pk_bf16_f32 v44, v64, v65
  v_rcp_f32 v67, v67
  v_mfma_f32_16x16x32_bf16 a[184:187], v[40:43], a[120:123], a[184:187]
  v_rcp_f32 v68, v68
  v_mfma_f32_16x16x32_bf16 a[172:175], v[40:43], a[108:111], a[172:175]
  v_cvt_pk_bf16_f32 v45, v66, v67
  v_rcp_f32 v69, v69
  v_mfma_f32_16x16x32_bf16 a[188:191], v[40:43], a[124:127], a[188:191]
  v_rcp_f32 v70, v70
  v_mfma_f32_32x32x16_bf16 v[112:127], v[236:239], a[12:15], v[112:127]
  v_cvt_pk_bf16_f32 v46, v68, v69
  v_rcp_f32 v71, v71
  v_rcp_f32 v72, v72
  v_rcp_f32 v73, v73
  v_mfma_f32_32x32x16_bf16 v[112:127], v[240:243], a[16:19], v[112:127]
  v_cvt_pk_bf16_f32 v47, v70, v71
  v_rcp_f32 v74, v74
  v_cvt_pk_bf16_f32 v48, v72, v73
  v_rcp_f32 v75, v75
  v_mfma_f32_16x16x32_bf16 v[32:35], v[44:47], a[128:131], v[28:31]
  v_rcp_f32 v76, v76
  v_mfma_f32_32x32x16_bf16 v[112:127], v[244:247], a[20:23], v[112:127]
  v_cvt_pk_bf16_f32 v49, v74, v75
  v_rcp_f32 v77, v77
  v_rcp_f32 v78, v78
  v_rcp_f32 v79, v79
  v_mfma_f32_32x32x16_bf16 v[112:127], v[248:251], a[24:27], v[112:127]
  v_cvt_pk_bf16_f32 v50, v76, v77
  v_exp_f32 v84, v84
  v_cvt_pk_bf16_f32 v51, v78, v79
  v_exp_f32 v85, v85
  v_mfma_f32_32x32x16_bf16 v[112:127], v[252:255], a[28:31], v[112:127]
  v_exp_f32 v86, v86
  v_exp_f32 v87, v87
  v_exp_f32 v88, v88
  v_mfma_f32_16x16x32_bf16 v[32:35], v[48:51], a[132:135], v[32:35]
  v_exp_f32 v89, v89
  v_mfma_f32_32x32x16_bf16 v[112:127], v[60:63], a[198:201], v[112:127]
  v_exp_f32 v90, v90
  v_exp_f32 v91, v91
  v_exp_f32 v92, v92
  v_exp_f32 v93, v93
  v_exp_f32 v94, v94
  v_exp_f32 v95, v95
  ds_read_b128 v[36:39], v52 offset:4864
  v_exp_f32 v96, v96
  v_exp_f32 v97, v97
  v_mfma_f32_32x32x16_bf16 v[80:95], a[192:195], a[196:199], v[80:95]
  v_exp_f32 v98, v98
  v_exp_f32 v99, v99
  v_exp_f32 v100, v100
  v_exp_f32 v101, v101
  v_exp_f32 v102, v102
  v_exp_f32 v103, v103
  v_exp_f32 v104, v104
  v_exp_f32 v105, v105
  v_exp_f32 v106, v106
  v_exp_f32 v107, v107
  v_exp_f32 v108, v108
  v_exp_f32 v109, v109
  v_exp_f32 v110, v110
  v_exp_f32 v111, v111
  v_rcp_f32 v80, v80
  v_rcp_f32 v81, v81
  v_rcp_f32 v82, v82
  v_mfma_f32_32x32x16_bf16 v[96:111], a[192:195], a[196:199], v[96:111]
  v_cvt_pk_bf16_f32 v44, v80, v81
  v_rcp_f32 v83, v83
  v_rcp_f32 v84, v84
  v_rcp_f32 v85, v85
  v_cvt_pk_bf16_f32 v45, v82, v83
  v_rcp_f32 v86, v86
  v_rcp_f32 v87, v87
  v_cvt_pk_bf16_f32 v46, v84, v85
  v_rcp_f32 v88, v88
  v_rcp_f32 v89, v89
  v_cvt_pk_bf16_f32 v47, v86, v87
  v_rcp_f32 v90, v90
  v_rcp_f32 v91, v91
  v_mfma_f32_16x16x32_bf16 v[32:35], v[44:47], a[136:139], v[32:35]
  v_cvt_pk_bf16_f32 v48, v88, v89
  v_rcp_f32 v92, v92
  v_cvt_pk_bf16_f32 v49, v90, v91
  v_rcp_f32 v93, v93
  v_rcp_f32 v94, v94
  v_rcp_f32 v95, v95
  v_cvt_pk_bf16_f32 v50, v92, v93
  v_exp_f32 v112, v112
  v_exp_f32 v113, v113
  v_cvt_pk_bf16_f32 v51, v94, v95
  v_exp_f32 v114, v114
  v_exp_f32 v115, v115
  v_mfma_f32_16x16x32_bf16 v[32:35], v[48:51], a[140:143], v[32:35]
  v_exp_f32 v116, v116
  v_exp_f32 v117, v117
  v_exp_f32 v118, v118
  v_exp_f32 v119, v119
  v_exp_f32 v120, v120
  v_exp_f32 v121, v121
  v_exp_f32 v122, v122
  v_exp_f32 v123, v123
  v_exp_f32 v124, v124
  v_exp_f32 v125, v125
  v_exp_f32 v126, v126
  v_exp_f32 v127, v127
  v_rcp_f32 v96, v96
  v_rcp_f32 v97, v97
  v_rcp_f32 v98, v98
  v_mfma_f32_32x32x16_bf16 v[112:127], a[192:195], a[196:199], v[112:127]
  v_cvt_pk_bf16_f32 v44, v96, v97
  v_rcp_f32 v99, v99
  v_rcp_f32 v100, v100
  v_rcp_f32 v101, v101
  v_cvt_pk_bf16_f32 v45, v98, v99
  v_rcp_f32 v102, v102
  v_rcp_f32 v103, v103
  v_cvt_pk_bf16_f32 v46, v100, v101
  v_rcp_f32 v104, v104
  v_rcp_f32 v105, v105
  v_cvt_pk_bf16_f32 v47, v102, v103
  v_rcp_f32 v106, v106
  v_rcp_f32 v107, v107
  v_mfma_f32_16x16x32_bf16 v[32:35], v[44:47], a[144:147], v[32:35]
  v_cvt_pk_bf16_f32 v48, v104, v105
  v_rcp_f32 v108, v108
  v_cvt_pk_bf16_f32 v49, v106, v107
  v_rcp_f32 v109, v109
  v_rcp_f32 v110, v110
  v_rcp_f32 v111, v111
  v_cvt_pk_bf16_f32 v50, v108, v109
  v_rcp_f32 v112, v112
  v_rcp_f32 v113, v113
  v_cvt_pk_bf16_f32 v51, v110, v111
  v_rcp_f32 v114, v114
  v_rcp_f32 v115, v115
  v_mfma_f32_16x16x32_bf16 v[32:35], v[48:51], a[148:151], v[32:35]
  v_cvt_pk_bf16_f32 v44, v112, v113
  v_rcp_f32 v116, v116
  v_cvt_pk_bf16_f32 v45, v114, v115
  v_rcp_f32 v117, v117
  v_rcp_f32 v118, v118
  v_rcp_f32 v119, v119
  v_cvt_pk_bf16_f32 v46, v116, v117
  v_rcp_f32 v120, v120
  v_rcp_f32 v121, v121
  v_cvt_pk_bf16_f32 v47, v118, v119
  v_rcp_f32 v122, v122
  v_rcp_f32 v123, v123
  v_mfma_f32_16x16x32_bf16 v[32:35], v[44:47], a[152:155], v[32:35]
  v_cvt_pk_bf16_f32 v48, v120, v121
  v_rcp_f32 v124, v124
  v_cvt_pk_bf16_f32 v49, v122, v123
  v_rcp_f32 v125, v125
  v_rcp_f32 v126, v126
  v_rcp_f32 v127, v127
  v_cvt_pk_bf16_f32 v50, v124, v125
  v_mbcnt_lo_u32_b32 v66, -1, 0
  v_mbcnt_hi_u32_b32 v66, -1, v66
  v_cvt_pk_bf16_f32 v51, v126, v127
  v_lshlrev_b32 v66, 1, v66
  s_nop 0
  v_mfma_f32_16x16x32_bf16 v[32:35], v[48:51], a[156:159], v[32:35]
  s_waitcnt lgkmcnt(0)
  s_nop 6
  v_mul_legacy_f32 v32, v32, v36
  v_mul_legacy_f32 v33, v33, v37
  v_mul_legacy_f32 v34, v34, v38
  v_mul_legacy_f32 v35, v35, v39
  v_cvt_pk_bf16_f32 v40, v32, v33
  v_cvt_pk_bf16_f32 v41, v34, v35
  s_nop 0
  v_mov_b32_dpp v42, v40 quad_perm:[1,0,3,2] row_mask:0xf bank_mask:0xf
  v_mov_b32_dpp v43, v41 quad_perm:[1,0,3,2] row_mask:0xf bank_mask:0xf
  s_nop 1
  v_mfma_f32_16x16x32_bf16 a[160:163], v[40:43], a[64:67], a[160:163]
  v_mfma_f32_16x16x32_bf16 a[176:179], v[40:43], a[80:83], a[176:179]
  v_mfma_f32_16x16x32_bf16 a[164:167], v[40:43], a[68:71], a[164:167]
  v_mfma_f32_16x16x32_bf16 a[180:183], v[40:43], a[84:87], a[180:183]
  v_mfma_f32_16x16x32_bf16 a[168:171], v[40:43], a[72:75], a[168:171]
  v_mfma_f32_16x16x32_bf16 a[184:187], v[40:43], a[88:91], a[184:187]
  v_mfma_f32_16x16x32_bf16 a[172:175], v[40:43], a[76:79], a[172:175]
  v_mfma_f32_16x16x32_bf16 a[188:191], v[40:43], a[92:95], a[188:191]
  s_nop 0
  v_accvgpr_read_b32 v68, a160
  v_accvgpr_read_b32 v69, a176
  v_cvt_pk_bf16_f32 v64, v68, v69
  v_accvgpr_read_b32 v70, a164
  v_accvgpr_read_b32 v71, a180
  v_cvt_pk_bf16_f32 v70, v70, v71
  v_accvgpr_read_b32 v72, a168
  v_accvgpr_read_b32 v73, a184
  v_mov_b32_dpp v64, v70 quad_perm:[0,1,2,3] row_mask:0x2 bank_mask:0xf
  v_cvt_pk_bf16_f32 v72, v72, v73
  v_accvgpr_read_b32 v74, a172
  v_accvgpr_read_b32 v75, a188
  v_mov_b32_dpp v64, v72 quad_perm:[0,1,2,3] row_mask:0x4 bank_mask:0xf
  v_cvt_pk_bf16_f32 v74, v74, v75
  s_nop 1
  v_mov_b32_dpp v64, v74 quad_perm:[0,1,2,3] row_mask:0x8 bank_mask:0xf
  s_branch L_store

.section .rodata,"a"
.p2align 6
.amdhsa_kernel standalone__sequential_behavior_din__recsys_kernel
  .amdhsa_next_free_vgpr 512
  .amdhsa_next_free_sgpr 102
  .amdhsa_accum_offset 256
  .amdhsa_group_segment_fixed_size 0
  .amdhsa_kernarg_size 80
  .amdhsa_user_sgpr_count 2
  .amdhsa_user_sgpr_kernarg_segment_ptr 1
  .amdhsa_system_sgpr_workgroup_id_x 1
.end_amdhsa_kernel
```
